```python
import torch

def _softmax(x, axis=-1):
    return torch.softmax(x, dim=axis)
def _gelu(x):
    return torch.nn.functional.gelu(x, approximate="tanh")
def _silu(x):
    return torch.nn.functional.silu(x)
def _sigmoid(x):
    return torch.sigmoid(x)
def _layernorm(x, axis=-1, eps=1e-5):
    m = x.mean(dim=axis, keepdim=True)
    v = x.var(dim=axis, keepdim=True, unbiased=False)
    return (x - m) / torch.sqrt(v + eps)
def _scatter_add(tgt, idx, src, axis=0):
    return tgt.clone().index_add_(axis, idx, src)
def _segment_sum(src, seg, n):
    out = torch.zeros((n,) + src.shape[1:], dtype=src.dtype)
    return out.index_add_(0, seg, src)
def _pad(x, pw):
    flat = tuple(v for pair in reversed(pw) for v in pair)
    return torch.nn.functional.pad(x, flat)

kernel_name = 'standalone__layernorm_linear__sampling'

def setup_inputs():

    _w = (lambda a: (lambda t: t.to(torch.bfloat16) if t.is_floating_point() else t)(torch.as_tensor(a)))
    B, S, D = 512, 32, 640
    return {
        "x": _w((lambda *s: torch.randn(*s, dtype=torch.bfloat16) * 0.05)(B, S, D)),
        "g": _w((lambda *s: torch.randn(*s, dtype=torch.bfloat16) * 0.05)(D) + 1.0),
        "b": _w((lambda *s: torch.randn(*s, dtype=torch.bfloat16) * 0.4)(D)),
        "w": _w((lambda *s: torch.randn(*s, dtype=torch.bfloat16) * 0.05)(D, D)),
    }

def reference(x, g, b, w):
    return (_layernorm(x, axis=-1) * g + b) @ w
```

```asm
; @launch grid=(256,1,1) block=(256,1,1) lds=162944
.amdgcn_target "amdgcn-amd-amdhsa--gfx950"
.text
.globl standalone__layernorm_linear__sampling_kernel
.p2align 8
.type standalone__layernorm_linear__sampling_kernel,@function
standalone__layernorm_linear__sampling_kernel:
  s_load_dwordx2 s[16:17], s[0:1], 0x0
  s_load_dwordx4 s[4:7], s[0:1], 0x8
  s_load_dwordx2 s[20:21], s[0:1], 0x18
  s_load_dwordx2 s[24:25], s[0:1], 0x20
  s_cmp_ge_u32 s2, 0x100
  s_cbranch_scc1 L_end
  s_lshr_b32 s48, s2, 3
  s_getpc_b64 s[54:55]
L_pc:
  s_lshl_b32 s49, s48, 10
  v_lshlrev_b32 v18, 2, v0
  v_add_u32 v18, s49, v18
  v_lshlrev_b32 v19, 6, v0
  v_cmp_gt_u32 vcc, 128, v0
  v_lshl_add_u32 v18, v0, 2, v18
  v_subrev_u32 v18, 1024, v18
  v_cndmask_b32 v18, v18, v19, vcc
  v_min_u32 v18, L_end-L_pc-4, v18
  global_load_dword a255, v18, s[54:55]
  v_lshrrev_b32 v22, 4, v0
  v_and_b32 v21, 15, v0
  v_mul_u32_u24 v24, 1280, v22
  v_lshl_add_u32 v1, v21, 4, v24
  s_lshr_b32 s51, s2, 4
  s_and_b32 s49, s2, 7
  s_lshl3_add_u32 s36, s51, s49
  s_mul_i32 s36, s36, 163840
  s_lshr_b32 s3, s51, 2
  s_lshl_b32 s49, s3, 8
  s_add_u32 s28, s36, s49
  s_add_u32 s49, s36, 1024
  s_add_u32 s29, s28, 256
  s_add_u32 s30, s29, 256
  s_cmp_gt_u32 s30, s49
  s_cselect_b32 s30, s36, s30
  s_add_u32 s31, s30, 256
  s_cmp_gt_u32 s31, s49
  s_cselect_b32 s31, s36, s31
  s_add_u32 s32, s31, 256
  s_cmp_gt_u32 s32, s49
  s_cselect_b32 s32, s36, s32
  s_mov_b32 s18, 20971520
  s_mov_b32 s19, 0x20000
  s_lshl_b32 s49, s3, 8
  v_lshlrev_b32 v28, 3, v0
  v_min_u32 v28, 1272, v28
  v_add_u32 v28, s49, v28
  v_subrev_u32 v29, 1280, v28
  v_min_u32 v28, v28, v29
  s_waitcnt lgkmcnt(0)
  global_load_dwordx2 v[216:217], v28, s[4:5]
  global_load_dwordx2 v[218:219], v28, s[6:7]
  buffer_load_dwordx4 v[32:35], v1, s[16:19], s28 offen nt
  buffer_load_dwordx4 v[36:39], v1, s[16:19], s29 offen nt
  buffer_load_dwordx4 v[40:43], v1, s[16:19], s30 offen nt
  buffer_load_dwordx4 v[44:47], v1, s[16:19], s31 offen nt
  buffer_load_dwordx4 v[48:51], v1, s[16:19], s32 offen nt
  v_lshrrev_b32 v16, 6, v0
  v_and_b32 v17, 63, v0
  v_readfirstlane_b32 s45, v16
  s_and_b32 s50, s48, 1
  s_mul_i32 s50, s50, 640
  s_add_u32 s43, s36, s50
  v_add_u32 v1, 20480, v1
  buffer_load_dwordx4 v[52:55], v1, s[16:19], s28 offen nt
  buffer_load_dwordx4 v[56:59], v1, s[16:19], s29 offen nt
  buffer_load_dwordx4 v[60:63], v1, s[16:19], s30 offen nt
  s_and_b32 s8, s51, 3
  s_sub_u32 s33, s28, s36
  s_mul_i32 s33, s33, 640
  s_sub_u32 s34, s29, s36
  s_mul_i32 s34, s34, 640
  s_sub_u32 s35, s30, s36
  s_mul_i32 s35, s35, 640
  s_sub_u32 s38, s31, s36
  s_mul_i32 s38, s38, 640
  s_sub_u32 s41, s32, s36
  s_mul_i32 s41, s41, 640
  s_xor_b32 s9, s8, 0
  s_mul_i32 s9, s9, 40960
  s_xor_b32 s10, s8, 1
  s_mul_i32 s10, s10, 40960
  s_xor_b32 s11, s8, 2
  s_mul_i32 s11, s11, 40960
  s_xor_b32 s12, s8, 3
  s_mul_i32 s12, s12, 40960
  s_lshl_b32 s8, s8, 6
  s_mov_b32 s44, s43
  s_add_u32 s39, s43, 10240
  s_mul_i32 s40, s45, 6560
  s_mov_b32 s46, 0xffff0000
  s_mov_b32 s47, 0x3f803f80
  s_mov_b32 s52, 0x44200000
  s_mov_b32 s53, 0x4083126f
  s_mul_i32 s42, s45, 5248
  s_add_u32 s42, s42, 104960
  s_mov_b32 s22, 819200
  s_mov_b32 s23, 0x20000
  s_mov_b32 s26, 20971520
  s_mov_b32 s27, 0x20000
  v_lshrrev_b32 v20, 4, v17
  v_lshlrev_b32 v23, 4, v21
  v_lshrrev_b32 v24, 5, v0
  v_bfe_u32 v25, v0, 1, 4
  v_and_b32 v26, 1, v0
  v_lshlrev_b32 v27, 10, v24
  v_lshl_add_u32 v27, v26, 8, v27
  v_lshl_add_u32 v27, v25, 4, v27
  v_add_u32 v29, 146944, v27
  v_mul_u32_u24 v24, 1312, v22
  v_xor_b32 v25, s8, v23
  v_add_u32 v2, v24, v25
  v_mul_u32_u24 v24, 1312, v21
  v_lshl_add_u32 v3, v20, 4, v24
  v_add_u32 v4, 146944, v23
  v_lshlrev_b32 v24, 4, v17
  v_add_u32 v5, s40, v24
  s_add_u32 m0, s42, 20992
  s_add_u32 s13, s33, s9
  s_add_u32 s37, s13, 19456
  v_lshrrev_b32 v24, 3, v17
  v_and_b32 v25, 7, v17
  v_and_b32 v26, 6, v24
  v_xor_b32 v25, v25, v26
  v_lshlrev_b32 v25, 4, v25
  v_and_b32 v26, 4, v24
  v_add_u32 v24, v24, v26
  v_mul_u32_u24 v24, 1280, v24
  v_add_u32 v24, v24, v25
  v_lshl_add_u32 v24, v16, 7, v24
  v_add_u32 v6, s50, v24
  v_lshrrev_b32 v24, 1, v17
  v_mul_u32_u24 v24, 1280, v24
  v_and_b32 v25, 1, v17
  v_lshl_add_u32 v24, v25, 4, v24
  v_lshl_add_u32 v24, v16, 5, v24
  v_add_u32 v24, 512, v24
  v_add_u32 v7, s50, v24
  v_bfe_u32 v24, v17, 2, 3
  v_and_b32 v25, 3, v17
  v_lshrrev_b32 v26, 1, v24
  v_lshlrev_b32 v26, 5, v26
  v_lshl_add_u32 v26, v25, 3, v26
  v_lshl_add_u32 v26, v24, 7, v26
  v_lshrrev_b32 v27, 5, v17
  v_lshl_add_u32 v26, v27, 10, v26
  v_add_u32 v11, s42, v26
  v_xor_b32 v12, 32, v11
  v_xor_b32 v13, 64, v11
  v_xor_b32 v14, 96, v11
  v_bfe_u32 v24, v17, 2, 2
  v_lshl_add_u32 v26, v20, 3, v24
  v_lshlrev_b32 v26, 5, v26
  v_lshl_add_u32 v26, v25, 3, v26
  v_add_u32 v26, 4096, v26
  v_add_u32 v15, s42, v26
  v_lshrrev_b32 v24, 3, v17
  v_mul_u32_u24 v24, 1280, v24
  v_and_b32 v25, 7, v17
  v_lshl_add_u32 v24, v25, 4, v24
  v_lshl_add_u32 v8, v16, 7, v24
  v_mul_u32_u24 v24, 136, v21
  v_lshl_add_u32 v24, v20, 3, v24
  v_lshl_add_u32 v24, v16, 5, v24
  v_add_u32 v9, 152064, v24
  v_mul_u32_u24 v24, 136, v22
  v_lshl_add_u32 v24, v21, 3, v24
  v_add_u32 v10, 152064, v24
  v_mul_u32_u24 v24, 1280, v22
  v_lshl_add_u32 v24, v21, 3, v24
  v_add_u32 v0, 512, v24
  v_mov_b32 v31, 0
  buffer_load_dwordx4 v[64:67], v1, s[16:19], s31 offen nt
  buffer_load_dwordx4 v[68:71], v1, s[16:19], s32 offen nt
  v_add_u32 v1, 20480, v1
  s_waitcnt vmcnt(11)
  v_lshlrev_b32 v220, 16, v216
  v_and_b32 v221, s46, v216
  v_lshlrev_b32 v222, 16, v217
  v_and_b32 v223, s46, v217
  ds_write_b128 v29, v[220:223]
  s_waitcnt vmcnt(10)
  v_lshlrev_b32 v224, 16, v218
  v_and_b32 v225, s46, v218
  v_lshlrev_b32 v226, 16, v219
  v_and_b32 v227, s46, v219
  ds_write_b128 v29, v[224:227] offset:512
  v_mov_b32 v29, 0
  s_waitcnt lgkmcnt(0)
  s_barrier
  buffer_load_dwordx4 v[72:75], v1, s[16:19], s28 offen nt
  ds_read_b128 v[116:119], v4 offset:0
  ds_read_b128 v[120:123], v4 offset:256
  ds_read_b128 v[124:127], v4 offset:512
  ds_read_b128 v[128:131], v4 offset:768
  ds_read_b128 v[132:135], v4 offset:1024
  s_waitcnt vmcnt(10)
  v_dot2c_f32_bf16 v29, s47, v32
  ds_read_b128 v[136:139], v4 offset:1280
  v_dot2c_f32_bf16 v31, v32, v32
  v_dot2c_f32_bf16 v29, s47, v33
  ds_read_b128 v[140:143], v4 offset:1536
  v_dot2c_f32_bf16 v31, v33, v33
  v_dot2c_f32_bf16 v29, s47, v34
  ds_read_b128 v[144:147], v4 offset:1792
  v_dot2c_f32_bf16 v31, v34, v34
  v_dot2c_f32_bf16 v29, s47, v35
  v_dot2c_f32_bf16 v31, v35, v35
  ds_read_b128 v[148:151], v4 offset:2048
  v_lshlrev_b32 v216, 16, v32
  v_and_b32 v217, s46, v32
  v_lshlrev_b32 v218, 16, v33
  ds_read_b128 v[152:155], v4 offset:2304
  v_and_b32 v219, s46, v33
  v_lshlrev_b32 v220, 16, v34
  ds_read_b128 v[156:159], v4 offset:2560
  v_and_b32 v221, s46, v34
  v_lshlrev_b32 v222, 16, v35
  v_and_b32 v223, s46, v35
  ds_read_b128 v[160:163], v4 offset:2816
  buffer_load_dwordx4 v[76:79], v1, s[16:19], s29 offen nt
  ds_read_b128 v[164:167], v4 offset:3072
  s_waitcnt vmcnt(10)
  v_dot2c_f32_bf16 v29, s47, v36
  v_dot2c_f32_bf16 v31, v36, v36
  ds_read_b128 v[168:171], v4 offset:3328
  v_dot2c_f32_bf16 v29, s47, v37
  v_dot2c_f32_bf16 v31, v37, v37
  ds_read_b128 v[172:175], v4 offset:3584
  v_dot2c_f32_bf16 v29, s47, v38
  v_dot2c_f32_bf16 v31, v38, v38
  v_dot2c_f32_bf16 v29, s47, v39
  ds_read_b128 v[176:179], v4 offset:3840
  v_dot2c_f32_bf16 v31, v39, v39
  v_lshlrev_b32 v224, 16, v36
  v_and_b32 v225, s46, v36
  ds_read_b128 v[180:183], v4 offset:4096
  v_lshlrev_b32 v226, 16, v37
  v_and_b32 v227, s46, v37
  ds_read_b128 v[184:187], v4 offset:4352
  v_lshlrev_b32 v228, 16, v38
  v_and_b32 v229, s46, v38
  v_lshlrev_b32 v230, 16, v39
  ds_read_b128 v[188:191], v4 offset:4608
  v_and_b32 v231, s46, v39
  ds_read_b128 v[192:195], v4 offset:4864
  buffer_load_dwordx4 v[80:83], v1, s[16:19], s30 offen nt
  s_waitcnt vmcnt(10)
  v_dot2c_f32_bf16 v29, s47, v40
  v_dot2c_f32_bf16 v31, v40, v40
  v_dot2c_f32_bf16 v29, s47, v41
  v_dot2c_f32_bf16 v31, v41, v41
  v_dot2c_f32_bf16 v29, s47, v42
  v_dot2c_f32_bf16 v31, v42, v42
  v_dot2c_f32_bf16 v29, s47, v43
  v_dot2c_f32_bf16 v31, v43, v43
  v_lshlrev_b32 v232, 16, v40
  v_and_b32 v233, s46, v40
  v_lshlrev_b32 v234, 16, v41
  v_and_b32 v235, s46, v41
  buffer_load_dwordx4 v[84:87], v1, s[16:19], s31 offen nt
  s_waitcnt vmcnt(10)
  v_dot2c_f32_bf16 v29, s47, v44
  v_dot2c_f32_bf16 v31, v44, v44
  v_dot2c_f32_bf16 v29, s47, v45
  v_dot2c_f32_bf16 v31, v45, v45
  v_dot2c_f32_bf16 v29, s47, v46
  v_dot2c_f32_bf16 v31, v46, v46
  v_dot2c_f32_bf16 v29, s47, v47
  v_dot2c_f32_bf16 v31, v47, v47
  buffer_load_dwordx4 v[88:91], v1, s[16:19], s32 offen nt
  v_add_u32 v1, 20480, v1
  s_waitcnt vmcnt(10)
  v_dot2c_f32_bf16 v29, s47, v48
  v_dot2c_f32_bf16 v31, v48, v48
  v_dot2c_f32_bf16 v29, s47, v49
  v_dot2c_f32_bf16 v31, v49, v49
  v_dot2c_f32_bf16 v29, s47, v50
  v_dot2c_f32_bf16 v31, v50, v50
  v_dot2c_f32_bf16 v29, s47, v51
  v_dot2c_f32_bf16 v31, v51, v51
  s_nop 1
  v_add_f32_dpp v29, v29, v29 row_ror:8 row_mask:0xf bank_mask:0xf
  v_add_f32_dpp v31, v31, v31 row_ror:8 row_mask:0xf bank_mask:0xf
  s_nop 0
  v_add_f32_dpp v29, v29, v29 row_ror:4 row_mask:0xf bank_mask:0xf
  v_add_f32_dpp v31, v31, v31 row_ror:4 row_mask:0xf bank_mask:0xf
  s_nop 0
  v_add_f32_dpp v29, v29, v29 row_ror:2 row_mask:0xf bank_mask:0xf
  v_add_f32_dpp v31, v31, v31 row_ror:2 row_mask:0xf bank_mask:0xf
  s_nop 0
  v_add_f32_dpp v29, v29, v29 row_ror:1 row_mask:0xf bank_mask:0xf
  v_add_f32_dpp v31, v31, v31 row_ror:1 row_mask:0xf bank_mask:0xf
  v_mul_f32 v28, v29, v29
  v_fma_f32 v30, v29, v29, -v28
  v_fma_f32 v31, v31, s52, -v28
  v_sub_f32 v31, v31, v30
  v_max_f32 v31, 0, v31
  v_add_f32 v31, s53, v31
  v_rsq_f32 v31, v31
  s_nop 0
  v_mul_f32 v28, s52, v31
  v_fma_f32 v30, -v29, v31, 0
  v_pk_fma_f32 v[216:217], v[216:217], v[28:29], v[30:31] op_sel_hi:[1,0,0]
  v_pk_fma_f32 v[218:219], v[218:219], v[28:29], v[30:31] op_sel_hi:[1,0,0]
  buffer_load_dwordx4 v[92:95], v1, s[16:19], s28 offen nt
  s_waitcnt lgkmcnt(15)
  v_pk_fma_f32 v[216:217], v[216:217], v[116:117], v[124:125]
  v_pk_fma_f32 v[218:219], v[218:219], v[118:119], v[126:127]
  v_cvt_pk_bf16_f32 v32, v216, v217
  v_cvt_pk_bf16_f32 v33, v218, v219
  v_pk_fma_f32 v[220:221], v[220:221], v[28:29], v[30:31] op_sel_hi:[1,0,0]
  v_pk_fma_f32 v[222:223], v[222:223], v[28:29], v[30:31] op_sel_hi:[1,0,0]
  v_pk_fma_f32 v[220:221], v[220:221], v[120:121], v[128:129]
  v_pk_fma_f32 v[222:223], v[222:223], v[122:123], v[130:131]
  v_cvt_pk_bf16_f32 v34, v220, v221
  v_cvt_pk_bf16_f32 v35, v222, v223
  ds_write_b128 v2, v[32:35]
  v_pk_fma_f32 v[224:225], v[224:225], v[28:29], v[30:31] op_sel_hi:[1,0,0]
  v_pk_fma_f32 v[226:227], v[226:227], v[28:29], v[30:31] op_sel_hi:[1,0,0]
  s_waitcnt lgkmcnt(14)
  v_pk_fma_f32 v[224:225], v[224:225], v[132:133], v[140:141]
  v_pk_fma_f32 v[226:227], v[226:227], v[134:135], v[142:143]
  v_cvt_pk_bf16_f32 v36, v224, v225
  v_cvt_pk_bf16_f32 v37, v226, v227
  v_pk_fma_f32 v[228:229], v[228:229], v[28:29], v[30:31] op_sel_hi:[1,0,0]
  v_pk_fma_f32 v[230:231], v[230:231], v[28:29], v[30:31] op_sel_hi:[1,0,0]
  s_waitcnt lgkmcnt(13)
  v_pk_fma_f32 v[228:229], v[228:229], v[136:137], v[144:145]
  v_pk_fma_f32 v[230:231], v[230:231], v[138:139], v[146:147]
  v_cvt_pk_bf16_f32 v38, v228, v229
  v_cvt_pk_bf16_f32 v39, v230, v231
  ds_write_b128 v2, v[36:39] offset:256
  v_pk_fma_f32 v[232:233], v[232:233], v[28:29], v[30:31] op_sel_hi:[1,0,0]
  v_pk_fma_f32 v[234:235], v[234:235], v[28:29], v[30:31] op_sel_hi:[1,0,0]
  s_waitcnt lgkmcnt(11)
  v_pk_fma_f32 v[232:233], v[232:233], v[148:149], v[156:157]
  v_pk_fma_f32 v[234:235], v[234:235], v[150:151], v[158:159]
  v_cvt_pk_bf16_f32 v40, v232, v233
  v_cvt_pk_bf16_f32 v41, v234, v235
  v_lshlrev_b32 v216, 16, v42
  v_and_b32 v217, s46, v42
  v_lshlrev_b32 v218, 16, v43
  v_and_b32 v219, s46, v43
  v_pk_fma_f32 v[216:217], v[216:217], v[28:29], v[30:31] op_sel_hi:[1,0,0]
  v_pk_fma_f32 v[218:219], v[218:219], v[28:29], v[30:31] op_sel_hi:[1,0,0]
  s_waitcnt lgkmcnt(10)
  v_pk_fma_f32 v[216:217], v[216:217], v[152:153], v[160:161]
  v_pk_fma_f32 v[218:219], v[218:219], v[154:155], v[162:163]
  v_cvt_pk_bf16_f32 v42, v216, v217
  v_cvt_pk_bf16_f32 v43, v218, v219
  buffer_load_dwordx4 v[96:99], v1, s[16:19], s29 offen nt
  ds_write_b128 v2, v[40:43] offset:512
  v_lshlrev_b32 v220, 16, v44
  v_and_b32 v221, s46, v44
  v_lshlrev_b32 v222, 16, v45
  v_and_b32 v223, s46, v45
  v_pk_fma_f32 v[220:221], v[220:221], v[28:29], v[30:31] op_sel_hi:[1,0,0]
  v_pk_fma_f32 v[222:223], v[222:223], v[28:29], v[30:31] op_sel_hi:[1,0,0]
  s_waitcnt lgkmcnt(8)
  v_pk_fma_f32 v[220:221], v[220:221], v[164:165], v[172:173]
  v_pk_fma_f32 v[222:223], v[222:223], v[166:167], v[174:175]
  v_cvt_pk_bf16_f32 v44, v220, v221
  v_cvt_pk_bf16_f32 v45, v222, v223
  v_lshlrev_b32 v224, 16, v46
  v_and_b32 v225, s46, v46
  v_lshlrev_b32 v226, 16, v47
  v_and_b32 v227, s46, v47
  v_pk_fma_f32 v[224:225], v[224:225], v[28:29], v[30:31] op_sel_hi:[1,0,0]
  v_pk_fma_f32 v[226:227], v[226:227], v[28:29], v[30:31] op_sel_hi:[1,0,0]
  s_waitcnt lgkmcnt(7)
  v_pk_fma_f32 v[224:225], v[224:225], v[168:169], v[176:177]
  v_pk_fma_f32 v[226:227], v[226:227], v[170:171], v[178:179]
  v_cvt_pk_bf16_f32 v46, v224, v225
  v_cvt_pk_bf16_f32 v47, v226, v227
  ds_write_b128 v2, v[44:47] offset:768
  v_lshlrev_b32 v228, 16, v48
  buffer_load_dwordx4 v[100:103], v1, s[16:19], s30 offen nt
  v_and_b32 v229, s46, v48
  v_lshlrev_b32 v230, 16, v49
  v_and_b32 v231, s46, v49
  v_pk_fma_f32 v[228:229], v[228:229], v[28:29], v[30:31] op_sel_hi:[1,0,0]
  v_pk_fma_f32 v[230:231], v[230:231], v[28:29], v[30:31] op_sel_hi:[1,0,0]
  s_waitcnt lgkmcnt(5)
  v_pk_fma_f32 v[228:229], v[228:229], v[180:181], v[188:189]
  v_pk_fma_f32 v[230:231], v[230:231], v[182:183], v[190:191]
  v_cvt_pk_bf16_f32 v48, v228, v229
  v_cvt_pk_bf16_f32 v49, v230, v231
  v_lshlrev_b32 v232, 16, v50
  v_and_b32 v233, s46, v50
  v_lshlrev_b32 v234, 16, v51
  v_and_b32 v235, s46, v51
  v_pk_fma_f32 v[232:233], v[232:233], v[28:29], v[30:31] op_sel_hi:[1,0,0]
  v_pk_fma_f32 v[234:235], v[234:235], v[28:29], v[30:31] op_sel_hi:[1,0,0]
  s_waitcnt lgkmcnt(4)
  v_pk_fma_f32 v[232:233], v[232:233], v[184:185], v[192:193]
  v_pk_fma_f32 v[234:235], v[234:235], v[186:187], v[194:195]
  v_cvt_pk_bf16_f32 v50, v232, v233
  v_cvt_pk_bf16_f32 v51, v234, v235
  ds_write_b128 v2, v[48:51] offset:1024
  v_mov_b32 v29, 0
  v_mov_b32 v31, 0
  s_waitcnt vmcnt(12)
  v_dot2c_f32_bf16 v29, s47, v52
  v_dot2c_f32_bf16 v31, v52, v52
  v_dot2c_f32_bf16 v29, s47, v53
  buffer_load_dwordx4 v[104:107], v1, s[16:19], s31 offen nt
  v_dot2c_f32_bf16 v31, v53, v53
  v_dot2c_f32_bf16 v29, s47, v54
  v_dot2c_f32_bf16 v31, v54, v54
  v_dot2c_f32_bf16 v29, s47, v55
  v_dot2c_f32_bf16 v31, v55, v55
  s_waitcnt vmcnt(12)
  v_dot2c_f32_bf16 v29, s47, v56
  v_dot2c_f32_bf16 v31, v56, v56
  v_dot2c_f32_bf16 v29, s47, v57
  v_dot2c_f32_bf16 v31, v57, v57
  v_dot2c_f32_bf16 v29, s47, v58
  v_dot2c_f32_bf16 v31, v58, v58
  v_dot2c_f32_bf16 v29, s47, v59
  v_dot2c_f32_bf16 v31, v59, v59
  s_waitcnt vmcnt(11)
  v_dot2c_f32_bf16 v29, s47, v60
  v_dot2c_f32_bf16 v31, v60, v60
  v_dot2c_f32_bf16 v29, s47, v61
  v_dot2c_f32_bf16 v31, v61, v61
  v_dot2c_f32_bf16 v29, s47, v62
  v_dot2c_f32_bf16 v31, v62, v62
  v_dot2c_f32_bf16 v29, s47, v63
  v_dot2c_f32_bf16 v31, v63, v63
  s_waitcnt vmcnt(10)
  v_dot2c_f32_bf16 v29, s47, v64
  v_dot2c_f32_bf16 v31, v64, v64
  v_dot2c_f32_bf16 v29, s47, v65
  v_dot2c_f32_bf16 v31, v65, v65
  v_dot2c_f32_bf16 v29, s47, v66
  v_dot2c_f32_bf16 v31, v66, v66
  v_dot2c_f32_bf16 v29, s47, v67
  v_dot2c_f32_bf16 v31, v67, v67
  v_lshlrev_b32 v216, 16, v52
  buffer_load_dwordx4 v[108:111], v1, s[16:19], s32 offen nt
  v_add_u32 v1, 20480, v1
  s_waitcnt vmcnt(10)
  v_dot2c_f32_bf16 v29, s47, v68
  v_dot2c_f32_bf16 v31, v68, v68
  v_dot2c_f32_bf16 v29, s47, v69
  v_dot2c_f32_bf16 v31, v69, v69
  v_dot2c_f32_bf16 v29, s47, v70
  v_dot2c_f32_bf16 v31, v70, v70
  v_dot2c_f32_bf16 v29, s47, v71
  v_dot2c_f32_bf16 v31, v71, v71
  v_and_b32 v217, s46, v52
  s_nop 0
  v_add_f32_dpp v29, v29, v29 row_ror:8 row_mask:0xf bank_mask:0xf
  v_add_f32_dpp v31, v31, v31 row_ror:8 row_mask:0xf bank_mask:0xf
  v_lshlrev_b32 v218, 16, v53
  v_add_f32_dpp v29, v29, v29 row_ror:4 row_mask:0xf bank_mask:0xf
  v_add_f32_dpp v31, v31, v31 row_ror:4 row_mask:0xf bank_mask:0xf
  v_and_b32 v219, s46, v53
  v_add_f32_dpp v29, v29, v29 row_ror:2 row_mask:0xf bank_mask:0xf
  v_add_f32_dpp v31, v31, v31 row_ror:2 row_mask:0xf bank_mask:0xf
  s_nop 0
  v_add_f32_dpp v29, v29, v29 row_ror:1 row_mask:0xf bank_mask:0xf
  v_add_f32_dpp v31, v31, v31 row_ror:1 row_mask:0xf bank_mask:0xf
  v_mul_f32 v28, v29, v29
  v_fma_f32 v30, v29, v29, -v28
  v_fma_f32 v31, v31, s52, -v28
  v_sub_f32 v31, v31, v30
  v_max_f32 v31, 0, v31
  v_add_f32 v31, s53, v31
  v_rsq_f32 v31, v31
  s_nop 0
  v_mul_f32 v28, s52, v31
  v_fma_f32 v30, -v29, v31, 0
  v_pk_fma_f32 v[216:217], v[216:217], v[28:29], v[30:31] op_sel_hi:[1,0,0]
  buffer_load_dwordx4 v[196:199], v1, s[16:19], s28 offen nt
  v_pk_fma_f32 v[218:219], v[218:219], v[28:29], v[30:31] op_sel_hi:[1,0,0]
  v_pk_fma_f32 v[216:217], v[216:217], v[116:117], v[124:125]
  v_pk_fma_f32 v[218:219], v[218:219], v[118:119], v[126:127]
  v_cvt_pk_bf16_f32 v52, v216, v217
  v_cvt_pk_bf16_f32 v53, v218, v219
  v_lshlrev_b32 v220, 16, v54
  v_and_b32 v221, s46, v54
  v_lshlrev_b32 v222, 16, v55
  v_and_b32 v223, s46, v55
  v_pk_fma_f32 v[220:221], v[220:221], v[28:29], v[30:31] op_sel_hi:[1,0,0]
  v_pk_fma_f32 v[222:223], v[222:223], v[28:29], v[30:31] op_sel_hi:[1,0,0]
  v_pk_fma_f32 v[220:221], v[220:221], v[120:121], v[128:129]
  v_pk_fma_f32 v[222:223], v[222:223], v[122:123], v[130:131]
  v_cvt_pk_bf16_f32 v54, v220, v221
  v_cvt_pk_bf16_f32 v55, v222, v223
  ds_write_b128 v2, v[52:55] offset:20992
  v_lshlrev_b32 v224, 16, v56
  v_and_b32 v225, s46, v56
  v_lshlrev_b32 v226, 16, v57
  v_and_b32 v227, s46, v57
  v_pk_fma_f32 v[224:225], v[224:225], v[28:29], v[30:31] op_sel_hi:[1,0,0]
  v_pk_fma_f32 v[226:227], v[226:227], v[28:29], v[30:31] op_sel_hi:[1,0,0]
  v_pk_fma_f32 v[224:225], v[224:225], v[132:133], v[140:141]
  v_pk_fma_f32 v[226:227], v[226:227], v[134:135], v[142:143]
  v_cvt_pk_bf16_f32 v56, v224, v225
  v_cvt_pk_bf16_f32 v57, v226, v227
  v_lshlrev_b32 v228, 16, v58
  v_and_b32 v229, s46, v58
  v_lshlrev_b32 v230, 16, v59
  buffer_load_dwordx4 v[200:203], v1, s[16:19], s29 offen nt
  v_and_b32 v231, s46, v59
  v_pk_fma_f32 v[228:229], v[228:229], v[28:29], v[30:31] op_sel_hi:[1,0,0]
  v_pk_fma_f32 v[230:231], v[230:231], v[28:29], v[30:31] op_sel_hi:[1,0,0]
  v_pk_fma_f32 v[228:229], v[228:229], v[136:137], v[144:145]
  v_pk_fma_f32 v[230:231], v[230:231], v[138:139], v[146:147]
  v_cvt_pk_bf16_f32 v58, v228, v229
  v_cvt_pk_bf16_f32 v59, v230, v231
  ds_write_b128 v2, v[56:59] offset:21248
  v_lshlrev_b32 v232, 16, v60
  v_and_b32 v233, s46, v60
  v_lshlrev_b32 v234, 16, v61
  v_and_b32 v235, s46, v61
  v_pk_fma_f32 v[232:233], v[232:233], v[28:29], v[30:31] op_sel_hi:[1,0,0]
  v_pk_fma_f32 v[234:235], v[234:235], v[28:29], v[30:31] op_sel_hi:[1,0,0]
  v_pk_fma_f32 v[232:233], v[232:233], v[148:149], v[156:157]
  v_pk_fma_f32 v[234:235], v[234:235], v[150:151], v[158:159]
  v_cvt_pk_bf16_f32 v60, v232, v233
  v_cvt_pk_bf16_f32 v61, v234, v235
  v_lshlrev_b32 v216, 16, v62
  v_and_b32 v217, s46, v62
  v_lshlrev_b32 v218, 16, v63
  v_and_b32 v219, s46, v63
  v_pk_fma_f32 v[216:217], v[216:217], v[28:29], v[30:31] op_sel_hi:[1,0,0]
  v_pk_fma_f32 v[218:219], v[218:219], v[28:29], v[30:31] op_sel_hi:[1,0,0]
  v_pk_fma_f32 v[216:217], v[216:217], v[152:153], v[160:161]
  v_pk_fma_f32 v[218:219], v[218:219], v[154:155], v[162:163]
  v_cvt_pk_bf16_f32 v62, v216, v217
  v_cvt_pk_bf16_f32 v63, v218, v219
  ds_write_b128 v2, v[60:63] offset:21504
  v_lshlrev_b32 v220, 16, v64
  v_and_b32 v221, s46, v64
  v_lshlrev_b32 v222, 16, v65
  v_and_b32 v223, s46, v65
  v_pk_fma_f32 v[220:221], v[220:221], v[28:29], v[30:31] op_sel_hi:[1,0,0]
  v_pk_fma_f32 v[222:223], v[222:223], v[28:29], v[30:31] op_sel_hi:[1,0,0]
  v_pk_fma_f32 v[220:221], v[220:221], v[164:165], v[172:173]
  v_pk_fma_f32 v[222:223], v[222:223], v[166:167], v[174:175]
  v_cvt_pk_bf16_f32 v64, v220, v221
  v_cvt_pk_bf16_f32 v65, v222, v223
  v_lshlrev_b32 v224, 16, v66
  v_and_b32 v225, s46, v66
  v_lshlrev_b32 v226, 16, v67
  v_and_b32 v227, s46, v67
  v_pk_fma_f32 v[224:225], v[224:225], v[28:29], v[30:31] op_sel_hi:[1,0,0]
  v_pk_fma_f32 v[226:227], v[226:227], v[28:29], v[30:31] op_sel_hi:[1,0,0]
  buffer_load_dwordx4 v[204:207], v1, s[16:19], s30 offen nt
  v_pk_fma_f32 v[224:225], v[224:225], v[168:169], v[176:177]
  v_pk_fma_f32 v[226:227], v[226:227], v[170:171], v[178:179]
  v_cvt_pk_bf16_f32 v66, v224, v225
  v_cvt_pk_bf16_f32 v67, v226, v227
  ds_write_b128 v2, v[64:67] offset:21760
  v_lshlrev_b32 v228, 16, v68
  v_and_b32 v229, s46, v68
  v_lshlrev_b32 v230, 16, v69
  v_and_b32 v231, s46, v69
  v_pk_fma_f32 v[228:229], v[228:229], v[28:29], v[30:31] op_sel_hi:[1,0,0]
  v_pk_fma_f32 v[230:231], v[230:231], v[28:29], v[30:31] op_sel_hi:[1,0,0]
  v_pk_fma_f32 v[228:229], v[228:229], v[180:181], v[188:189]
  v_pk_fma_f32 v[230:231], v[230:231], v[182:183], v[190:191]
  v_cvt_pk_bf16_f32 v68, v228, v229
  v_cvt_pk_bf16_f32 v69, v230, v231
  v_lshlrev_b32 v232, 16, v70
  v_and_b32 v233, s46, v70
  v_lshlrev_b32 v234, 16, v71
  v_and_b32 v235, s46, v71
  v_pk_fma_f32 v[232:233], v[232:233], v[28:29], v[30:31] op_sel_hi:[1,0,0]
  v_pk_fma_f32 v[234:235], v[234:235], v[28:29], v[30:31] op_sel_hi:[1,0,0]
  v_pk_fma_f32 v[232:233], v[232:233], v[184:185], v[192:193]
  v_pk_fma_f32 v[234:235], v[234:235], v[186:187], v[194:195]
  v_cvt_pk_bf16_f32 v70, v232, v233
  v_cvt_pk_bf16_f32 v71, v234, v235
  ds_write_b128 v2, v[68:71] offset:22016
  buffer_load_dwordx4 v[208:211], v1, s[16:19], s31 offen nt
  v_mov_b32 v29, 0
  v_mov_b32 v31, 0
  s_waitcnt vmcnt(13)
  v_dot2c_f32_bf16 v29, s47, v72
  v_dot2c_f32_bf16 v31, v72, v72
  v_dot2c_f32_bf16 v29, s47, v73
  v_dot2c_f32_bf16 v31, v73, v73
  v_dot2c_f32_bf16 v29, s47, v74
  v_dot2c_f32_bf16 v31, v74, v74
  v_dot2c_f32_bf16 v29, s47, v75
  v_dot2c_f32_bf16 v31, v75, v75
  s_waitcnt vmcnt(12)
  v_dot2c_f32_bf16 v29, s47, v76
  v_dot2c_f32_bf16 v31, v76, v76
  v_dot2c_f32_bf16 v29, s47, v77
  v_dot2c_f32_bf16 v31, v77, v77
  v_dot2c_f32_bf16 v29, s47, v78
  v_dot2c_f32_bf16 v31, v78, v78
  v_dot2c_f32_bf16 v29, s47, v79
  v_dot2c_f32_bf16 v31, v79, v79
  s_waitcnt vmcnt(11)
  v_dot2c_f32_bf16 v29, s47, v80
  v_dot2c_f32_bf16 v31, v80, v80
  v_dot2c_f32_bf16 v29, s47, v81
  v_dot2c_f32_bf16 v31, v81, v81
  v_dot2c_f32_bf16 v29, s47, v82
  v_dot2c_f32_bf16 v31, v82, v82
  v_dot2c_f32_bf16 v29, s47, v83
  v_dot2c_f32_bf16 v31, v83, v83
  s_waitcnt vmcnt(10)
  v_dot2c_f32_bf16 v29, s47, v84
  buffer_load_dwordx4 v[212:215], v1, s[16:19], s32 offen nt
  v_add_u32 v1, 20480, v1
  v_dot2c_f32_bf16 v31, v84, v84
  v_dot2c_f32_bf16 v29, s47, v85
  v_dot2c_f32_bf16 v31, v85, v85
  v_dot2c_f32_bf16 v29, s47, v86
  v_dot2c_f32_bf16 v31, v86, v86
  v_dot2c_f32_bf16 v29, s47, v87
  v_dot2c_f32_bf16 v31, v87, v87
  s_waitcnt vmcnt(10)
  v_dot2c_f32_bf16 v29, s47, v88
  v_dot2c_f32_bf16 v31, v88, v88
  v_dot2c_f32_bf16 v29, s47, v89
  v_dot2c_f32_bf16 v31, v89, v89
  v_dot2c_f32_bf16 v29, s47, v90
  v_dot2c_f32_bf16 v31, v90, v90
  v_dot2c_f32_bf16 v29, s47, v91
  v_dot2c_f32_bf16 v31, v91, v91
  v_lshlrev_b32 v216, 16, v72
  v_and_b32 v217, s46, v72
  v_add_f32_dpp v29, v29, v29 row_ror:8 row_mask:0xf bank_mask:0xf
  v_add_f32_dpp v31, v31, v31 row_ror:8 row_mask:0xf bank_mask:0xf
  v_lshlrev_b32 v218, 16, v73
  v_add_f32_dpp v29, v29, v29 row_ror:4 row_mask:0xf bank_mask:0xf
  v_add_f32_dpp v31, v31, v31 row_ror:4 row_mask:0xf bank_mask:0xf
  v_and_b32 v219, s46, v73
  v_add_f32_dpp v29, v29, v29 row_ror:2 row_mask:0xf bank_mask:0xf
  v_add_f32_dpp v31, v31, v31 row_ror:2 row_mask:0xf bank_mask:0xf
  s_nop 0
  v_add_f32_dpp v29, v29, v29 row_ror:1 row_mask:0xf bank_mask:0xf
  v_add_f32_dpp v31, v31, v31 row_ror:1 row_mask:0xf bank_mask:0xf
  v_mul_f32 v28, v29, v29
  v_fma_f32 v30, v29, v29, -v28
  v_fma_f32 v31, v31, s52, -v28
  v_sub_f32 v31, v31, v30
  buffer_load_dwordx4 v[236:239], v1, s[16:19], s28 offen nt
  v_max_f32 v31, 0, v31
  v_add_f32 v31, s53, v31
  v_rsq_f32 v31, v31
  s_nop 0
  v_mul_f32 v28, s52, v31
  v_fma_f32 v30, -v29, v31, 0
  v_pk_fma_f32 v[216:217], v[216:217], v[28:29], v[30:31] op_sel_hi:[1,0,0]
  v_pk_fma_f32 v[218:219], v[218:219], v[28:29], v[30:31] op_sel_hi:[1,0,0]
  v_pk_fma_f32 v[216:217], v[216:217], v[116:117], v[124:125]
  v_pk_fma_f32 v[218:219], v[218:219], v[118:119], v[126:127]
  v_cvt_pk_bf16_f32 v72, v216, v217
  v_cvt_pk_bf16_f32 v73, v218, v219
  v_lshlrev_b32 v220, 16, v74
  v_and_b32 v221, s46, v74
  v_lshlrev_b32 v222, 16, v75
  v_and_b32 v223, s46, v75
  v_pk_fma_f32 v[220:221], v[220:221], v[28:29], v[30:31] op_sel_hi:[1,0,0]
  v_pk_fma_f32 v[222:223], v[222:223], v[28:29], v[30:31] op_sel_hi:[1,0,0]
  v_pk_fma_f32 v[220:221], v[220:221], v[120:121], v[128:129]
  v_pk_fma_f32 v[222:223], v[222:223], v[122:123], v[130:131]
  v_cvt_pk_bf16_f32 v74, v220, v221
  v_cvt_pk_bf16_f32 v75, v222, v223
  ds_write_b128 v2, v[72:75] offset:41984
  v_lshlrev_b32 v224, 16, v76
  v_and_b32 v225, s46, v76
  v_lshlrev_b32 v226, 16, v77
  v_and_b32 v227, s46, v77
  v_pk_fma_f32 v[224:225], v[224:225], v[28:29], v[30:31] op_sel_hi:[1,0,0]
  buffer_load_dwordx4 v[240:243], v1, s[16:19], s29 offen nt
  v_pk_fma_f32 v[226:227], v[226:227], v[28:29], v[30:31] op_sel_hi:[1,0,0]
  v_pk_fma_f32 v[224:225], v[224:225], v[132:133], v[140:141]
  v_pk_fma_f32 v[226:227], v[226:227], v[134:135], v[142:143]
  v_cvt_pk_bf16_f32 v76, v224, v225
  v_cvt_pk_bf16_f32 v77, v226, v227
  v_lshlrev_b32 v228, 16, v78
  v_and_b32 v229, s46, v78
  v_lshlrev_b32 v230, 16, v79
  v_and_b32 v231, s46, v79
  v_pk_fma_f32 v[228:229], v[228:229], v[28:29], v[30:31] op_sel_hi:[1,0,0]
  v_pk_fma_f32 v[230:231], v[230:231], v[28:29], v[30:31] op_sel_hi:[1,0,0]
  v_pk_fma_f32 v[228:229], v[228:229], v[136:137], v[144:145]
  v_pk_fma_f32 v[230:231], v[230:231], v[138:139], v[146:147]
  v_cvt_pk_bf16_f32 v78, v228, v229
  v_cvt_pk_bf16_f32 v79, v230, v231
  ds_write_b128 v2, v[76:79] offset:42240
  v_lshlrev_b32 v232, 16, v80
  v_and_b32 v233, s46, v80
  v_lshlrev_b32 v234, 16, v81
  v_and_b32 v235, s46, v81
  v_pk_fma_f32 v[232:233], v[232:233], v[28:29], v[30:31] op_sel_hi:[1,0,0]
  v_pk_fma_f32 v[234:235], v[234:235], v[28:29], v[30:31] op_sel_hi:[1,0,0]
  v_pk_fma_f32 v[232:233], v[232:233], v[148:149], v[156:157]
  v_pk_fma_f32 v[234:235], v[234:235], v[150:151], v[158:159]
  v_cvt_pk_bf16_f32 v80, v232, v233
  v_cvt_pk_bf16_f32 v81, v234, v235
  v_lshlrev_b32 v216, 16, v82
  v_and_b32 v217, s46, v82
  buffer_load_dwordx4 v[244:247], v1, s[16:19], s30 offen nt
  v_lshlrev_b32 v218, 16, v83
  v_and_b32 v219, s46, v83
  v_pk_fma_f32 v[216:217], v[216:217], v[28:29], v[30:31] op_sel_hi:[1,0,0]
  v_pk_fma_f32 v[218:219], v[218:219], v[28:29], v[30:31] op_sel_hi:[1,0,0]
  v_pk_fma_f32 v[216:217], v[216:217], v[152:153], v[160:161]
  v_pk_fma_f32 v[218:219], v[218:219], v[154:155], v[162:163]
  v_cvt_pk_bf16_f32 v82, v216, v217
  v_cvt_pk_bf16_f32 v83, v218, v219
  ds_write_b128 v2, v[80:83] offset:42496
  v_lshlrev_b32 v220, 16, v84
  v_and_b32 v221, s46, v84
  v_lshlrev_b32 v222, 16, v85
  v_and_b32 v223, s46, v85
  v_pk_fma_f32 v[220:221], v[220:221], v[28:29], v[30:31] op_sel_hi:[1,0,0]
  v_pk_fma_f32 v[222:223], v[222:223], v[28:29], v[30:31] op_sel_hi:[1,0,0]
  v_pk_fma_f32 v[220:221], v[220:221], v[164:165], v[172:173]
  v_pk_fma_f32 v[222:223], v[222:223], v[166:167], v[174:175]
  v_cvt_pk_bf16_f32 v84, v220, v221
  v_cvt_pk_bf16_f32 v85, v222, v223
  v_lshlrev_b32 v224, 16, v86
  v_and_b32 v225, s46, v86
  v_lshlrev_b32 v226, 16, v87
  v_and_b32 v227, s46, v87
  v_pk_fma_f32 v[224:225], v[224:225], v[28:29], v[30:31] op_sel_hi:[1,0,0]
  v_pk_fma_f32 v[226:227], v[226:227], v[28:29], v[30:31] op_sel_hi:[1,0,0]
  v_pk_fma_f32 v[224:225], v[224:225], v[168:169], v[176:177]
  v_pk_fma_f32 v[226:227], v[226:227], v[170:171], v[178:179]
  v_cvt_pk_bf16_f32 v86, v224, v225
  v_cvt_pk_bf16_f32 v87, v226, v227
  ds_write_b128 v2, v[84:87] offset:42752
  v_lshlrev_b32 v228, 16, v88
  v_and_b32 v229, s46, v88
  v_lshlrev_b32 v230, 16, v89
  v_and_b32 v231, s46, v89
  v_pk_fma_f32 v[228:229], v[228:229], v[28:29], v[30:31] op_sel_hi:[1,0,0]
  v_pk_fma_f32 v[230:231], v[230:231], v[28:29], v[30:31] op_sel_hi:[1,0,0]
  v_pk_fma_f32 v[228:229], v[228:229], v[180:181], v[188:189]
  v_pk_fma_f32 v[230:231], v[230:231], v[182:183], v[190:191]
  v_cvt_pk_bf16_f32 v88, v228, v229
  v_cvt_pk_bf16_f32 v89, v230, v231
  v_lshlrev_b32 v232, 16, v90
  v_and_b32 v233, s46, v90
  v_lshlrev_b32 v234, 16, v91
  v_and_b32 v235, s46, v91
  v_pk_fma_f32 v[232:233], v[232:233], v[28:29], v[30:31] op_sel_hi:[1,0,0]
  v_pk_fma_f32 v[234:235], v[234:235], v[28:29], v[30:31] op_sel_hi:[1,0,0]
  buffer_load_dwordx4 v[248:251], v1, s[16:19], s31 offen nt
  v_pk_fma_f32 v[232:233], v[232:233], v[184:185], v[192:193]
  v_pk_fma_f32 v[234:235], v[234:235], v[186:187], v[194:195]
  v_cvt_pk_bf16_f32 v90, v232, v233
  v_cvt_pk_bf16_f32 v91, v234, v235
  ds_write_b128 v2, v[88:91] offset:43008
  v_mov_b32 v29, 0
  v_mov_b32 v31, 0
  s_waitcnt vmcnt(13)
  v_dot2c_f32_bf16 v29, s47, v92
  v_dot2c_f32_bf16 v31, v92, v92
  v_dot2c_f32_bf16 v29, s47, v93
  v_dot2c_f32_bf16 v31, v93, v93
  v_dot2c_f32_bf16 v29, s47, v94
  v_dot2c_f32_bf16 v31, v94, v94
  v_dot2c_f32_bf16 v29, s47, v95
  v_dot2c_f32_bf16 v31, v95, v95
  s_waitcnt vmcnt(12)
  v_dot2c_f32_bf16 v29, s47, v96
  v_dot2c_f32_bf16 v31, v96, v96
  v_dot2c_f32_bf16 v29, s47, v97
  v_dot2c_f32_bf16 v31, v97, v97
  v_dot2c_f32_bf16 v29, s47, v98
  v_dot2c_f32_bf16 v31, v98, v98
  v_dot2c_f32_bf16 v29, s47, v99
  v_dot2c_f32_bf16 v31, v99, v99
  s_waitcnt vmcnt(11)
  v_dot2c_f32_bf16 v29, s47, v100
  v_dot2c_f32_bf16 v31, v100, v100
  v_dot2c_f32_bf16 v29, s47, v101
  buffer_load_dwordx4 v[252:255], v1, s[16:19], s32 offen nt
  v_add_u32 v1, 20480, v1
  v_dot2c_f32_bf16 v31, v101, v101
  v_dot2c_f32_bf16 v29, s47, v102
  v_dot2c_f32_bf16 v31, v102, v102
  v_dot2c_f32_bf16 v29, s47, v103
  v_dot2c_f32_bf16 v31, v103, v103
  s_waitcnt vmcnt(11)
  v_dot2c_f32_bf16 v29, s47, v104
  v_dot2c_f32_bf16 v31, v104, v104
  v_dot2c_f32_bf16 v29, s47, v105
  v_dot2c_f32_bf16 v31, v105, v105
  v_dot2c_f32_bf16 v29, s47, v106
  v_dot2c_f32_bf16 v31, v106, v106
  v_dot2c_f32_bf16 v29, s47, v107
  v_dot2c_f32_bf16 v31, v107, v107
  s_waitcnt vmcnt(10)
  v_dot2c_f32_bf16 v29, s47, v108
  v_dot2c_f32_bf16 v31, v108, v108
  v_dot2c_f32_bf16 v29, s47, v109
  v_dot2c_f32_bf16 v31, v109, v109
  v_dot2c_f32_bf16 v29, s47, v110
  v_dot2c_f32_bf16 v31, v110, v110
  v_dot2c_f32_bf16 v29, s47, v111
  v_dot2c_f32_bf16 v31, v111, v111
  v_lshlrev_b32 v216, 16, v92
  v_and_b32 v217, s46, v92
  v_add_f32_dpp v29, v29, v29 row_ror:8 row_mask:0xf bank_mask:0xf
  v_add_f32_dpp v31, v31, v31 row_ror:8 row_mask:0xf bank_mask:0xf
  v_lshlrev_b32 v218, 16, v93
  v_add_f32_dpp v29, v29, v29 row_ror:4 row_mask:0xf bank_mask:0xf
  v_add_f32_dpp v31, v31, v31 row_ror:4 row_mask:0xf bank_mask:0xf
  v_and_b32 v219, s46, v93
  buffer_load_dwordx4 v6, s[20:23], s13 offen lds
  v_add_f32_dpp v29, v29, v29 row_ror:2 row_mask:0xf bank_mask:0xf
  v_add_f32_dpp v31, v31, v31 row_ror:2 row_mask:0xf bank_mask:0xf
  s_nop 0
  v_add_f32_dpp v29, v29, v29 row_ror:1 row_mask:0xf bank_mask:0xf
  v_add_f32_dpp v31, v31, v31 row_ror:1 row_mask:0xf bank_mask:0xf
  v_mul_f32 v28, v29, v29
  v_fma_f32 v30, v29, v29, -v28
  v_fma_f32 v31, v31, s52, -v28
  v_sub_f32 v31, v31, v30
  v_max_f32 v31, 0, v31
  v_add_f32 v31, s53, v31
  v_rsq_f32 v31, v31
  s_nop 0
  v_mul_f32 v28, s52, v31
  v_fma_f32 v30, -v29, v31, 0
  v_pk_fma_f32 v[216:217], v[216:217], v[28:29], v[30:31] op_sel_hi:[1,0,0]
  v_pk_fma_f32 v[218:219], v[218:219], v[28:29], v[30:31] op_sel_hi:[1,0,0]
  v_pk_fma_f32 v[216:217], v[216:217], v[116:117], v[124:125]
  v_pk_fma_f32 v[218:219], v[218:219], v[118:119], v[126:127]
  v_cvt_pk_bf16_f32 v92, v216, v217
  v_cvt_pk_bf16_f32 v93, v218, v219
  v_lshlrev_b32 v220, 16, v94
  v_and_b32 v221, s46, v94
  v_lshlrev_b32 v222, 16, v95
  v_and_b32 v223, s46, v95
  v_pk_fma_f32 v[220:221], v[220:221], v[28:29], v[30:31] op_sel_hi:[1,0,0]
  v_pk_fma_f32 v[222:223], v[222:223], v[28:29], v[30:31] op_sel_hi:[1,0,0]
  v_pk_fma_f32 v[220:221], v[220:221], v[120:121], v[128:129]
  v_pk_fma_f32 v[222:223], v[222:223], v[122:123], v[130:131]
  v_cvt_pk_bf16_f32 v94, v220, v221
  v_cvt_pk_bf16_f32 v95, v222, v223
  ds_write_b128 v2, v[92:95] offset:62976
  buffer_load_dwordx4 v6, s[20:23], s37 offen offset:1024 lds
  s_add_u32 s37, s13, 3072
  v_lshlrev_b32 v224, 16, v96
  v_and_b32 v225, s46, v96
  v_lshlrev_b32 v226, 16, v97
  v_and_b32 v227, s46, v97
  v_pk_fma_f32 v[224:225], v[224:225], v[28:29], v[30:31] op_sel_hi:[1,0,0]
  v_pk_fma_f32 v[226:227], v[226:227], v[28:29], v[30:31] op_sel_hi:[1,0,0]
  v_pk_fma_f32 v[224:225], v[224:225], v[132:133], v[140:141]
  v_pk_fma_f32 v[226:227], v[226:227], v[134:135], v[142:143]
  v_cvt_pk_bf16_f32 v96, v224, v225
  v_cvt_pk_bf16_f32 v97, v226, v227
  v_lshlrev_b32 v228, 16, v98
  v_and_b32 v229, s46, v98
  v_lshlrev_b32 v230, 16, v99
  v_and_b32 v231, s46, v99
  v_pk_fma_f32 v[228:229], v[228:229], v[28:29], v[30:31] op_sel_hi:[1,0,0]
  v_pk_fma_f32 v[230:231], v[230:231], v[28:29], v[30:31] op_sel_hi:[1,0,0]
  v_pk_fma_f32 v[228:229], v[228:229], v[136:137], v[144:145]
  v_pk_fma_f32 v[230:231], v[230:231], v[138:139], v[146:147]
  v_cvt_pk_bf16_f32 v98, v228, v229
  v_cvt_pk_bf16_f32 v99, v230, v231
  ds_write_b128 v2, v[96:99] offset:63232
  v_lshlrev_b32 v232, 16, v100
  v_and_b32 v233, s46, v100
  v_lshlrev_b32 v234, 16, v101
  buffer_load_dwordx4 v6, s[20:23], s37 offen offset:2048 lds
  s_add_u32 s37, s13, 22528
  v_and_b32 v235, s46, v101
  v_pk_fma_f32 v[232:233], v[232:233], v[28:29], v[30:31] op_sel_hi:[1,0,0]
  v_pk_fma_f32 v[234:235], v[234:235], v[28:29], v[30:31] op_sel_hi:[1,0,0]
  v_pk_fma_f32 v[232:233], v[232:233], v[148:149], v[156:157]
  v_pk_fma_f32 v[234:235], v[234:235], v[150:151], v[158:159]
  v_cvt_pk_bf16_f32 v100, v232, v233
  v_cvt_pk_bf16_f32 v101, v234, v235
  v_lshlrev_b32 v216, 16, v102
  v_and_b32 v217, s46, v102
  v_lshlrev_b32 v218, 16, v103
  v_and_b32 v219, s46, v103
  v_pk_fma_f32 v[216:217], v[216:217], v[28:29], v[30:31] op_sel_hi:[1,0,0]
  v_pk_fma_f32 v[218:219], v[218:219], v[28:29], v[30:31] op_sel_hi:[1,0,0]
  v_pk_fma_f32 v[216:217], v[216:217], v[152:153], v[160:161]
  v_pk_fma_f32 v[218:219], v[218:219], v[154:155], v[162:163]
  v_cvt_pk_bf16_f32 v102, v216, v217
  v_cvt_pk_bf16_f32 v103, v218, v219
  ds_write_b128 v2, v[100:103] offset:63488
  v_lshlrev_b32 v220, 16, v104
  v_and_b32 v221, s46, v104
  v_lshlrev_b32 v222, 16, v105
  v_and_b32 v223, s46, v105
  v_pk_fma_f32 v[220:221], v[220:221], v[28:29], v[30:31] op_sel_hi:[1,0,0]
  v_pk_fma_f32 v[222:223], v[222:223], v[28:29], v[30:31] op_sel_hi:[1,0,0]
  v_pk_fma_f32 v[220:221], v[220:221], v[164:165], v[172:173]
  v_pk_fma_f32 v[222:223], v[222:223], v[166:167], v[174:175]
  v_cvt_pk_bf16_f32 v104, v220, v221
  v_cvt_pk_bf16_f32 v105, v222, v223
  buffer_load_dwordx4 v6, s[20:23], s37 offen offset:3072 lds
  s_add_u32 m0, s42, 25088
  v_lshlrev_b32 v224, 16, v106
  v_and_b32 v225, s46, v106
  v_lshlrev_b32 v226, 16, v107
  v_and_b32 v227, s46, v107
  v_pk_fma_f32 v[224:225], v[224:225], v[28:29], v[30:31] op_sel_hi:[1,0,0]
  v_pk_fma_f32 v[226:227], v[226:227], v[28:29], v[30:31] op_sel_hi:[1,0,0]
  v_pk_fma_f32 v[224:225], v[224:225], v[168:169], v[176:177]
  v_pk_fma_f32 v[226:227], v[226:227], v[170:171], v[178:179]
  v_cvt_pk_bf16_f32 v106, v224, v225
  v_cvt_pk_bf16_f32 v107, v226, v227
  ds_write_b128 v2, v[104:107] offset:63744
  v_lshlrev_b32 v228, 16, v108
  v_and_b32 v229, s46, v108
  v_lshlrev_b32 v230, 16, v109
  v_and_b32 v231, s46, v109
  v_pk_fma_f32 v[228:229], v[228:229], v[28:29], v[30:31] op_sel_hi:[1,0,0]
  v_pk_fma_f32 v[230:231], v[230:231], v[28:29], v[30:31] op_sel_hi:[1,0,0]
  v_pk_fma_f32 v[228:229], v[228:229], v[180:181], v[188:189]
  v_pk_fma_f32 v[230:231], v[230:231], v[182:183], v[190:191]
  v_cvt_pk_bf16_f32 v108, v228, v229
  v_cvt_pk_bf16_f32 v109, v230, v231
  v_lshlrev_b32 v232, 16, v110
  v_and_b32 v233, s46, v110
  v_lshlrev_b32 v234, 16, v111
  v_and_b32 v235, s46, v111
  v_pk_fma_f32 v[232:233], v[232:233], v[28:29], v[30:31] op_sel_hi:[1,0,0]
  v_pk_fma_f32 v[234:235], v[234:235], v[28:29], v[30:31] op_sel_hi:[1,0,0]
  v_pk_fma_f32 v[232:233], v[232:233], v[184:185], v[192:193]
  v_pk_fma_f32 v[234:235], v[234:235], v[186:187], v[194:195]
  v_cvt_pk_bf16_f32 v110, v232, v233
  v_cvt_pk_bf16_f32 v111, v234, v235
  ds_write_b128 v2, v[108:111] offset:64000
  v_add_u32 v2, 62976, v2
  v_mov_b32 v29, 0
  v_mov_b32 v31, 0
  s_waitcnt vmcnt(13)
  v_dot2c_f32_bf16 v29, s47, v196
  v_dot2c_f32_bf16 v31, v196, v196
  v_dot2c_f32_bf16 v29, s47, v197
  v_dot2c_f32_bf16 v31, v197, v197
  v_dot2c_f32_bf16 v29, s47, v198
  v_dot2c_f32_bf16 v31, v198, v198
  v_dot2c_f32_bf16 v29, s47, v199
  v_dot2c_f32_bf16 v31, v199, v199
  s_waitcnt vmcnt(12)
  v_dot2c_f32_bf16 v29, s47, v200
  buffer_load_dwordx4 v7, s[20:23], s13 offen lds
  s_add_u32 m0, s42, 0
  s_add_u32 s13, s33, s10
  s_add_u32 s37, s13, 19456
  v_dot2c_f32_bf16 v31, v200, v200
  v_dot2c_f32_bf16 v29, s47, v201
  s_waitcnt lgkmcnt(0)
  s_barrier
  ds_read_b128 v[16:19], v3
  ds_read_b128 v[20:23], v3 offset:20992
  ds_read_b128 v[24:27], v3 offset:41984
  v_dot2c_f32_bf16 v31, v201, v201
  v_dot2c_f32_bf16 v29, s47, v202
  v_dot2c_f32_bf16 v31, v202, v202
  v_dot2c_f32_bf16 v29, s47, v203
  v_dot2c_f32_bf16 v31, v203, v203
  s_waitcnt vmcnt(12)
  v_dot2c_f32_bf16 v29, s47, v204
  v_dot2c_f32_bf16 v31, v204, v204
  v_dot2c_f32_bf16 v29, s47, v205
  v_dot2c_f32_bf16 v31, v205, v205
  v_dot2c_f32_bf16 v29, s47, v206
  v_dot2c_f32_bf16 v31, v206, v206
  v_dot2c_f32_bf16 v29, s47, v207
  v_dot2c_f32_bf16 v31, v207, v207
  s_waitcnt vmcnt(11)
  v_dot2c_f32_bf16 v29, s47, v208
  v_dot2c_f32_bf16 v31, v208, v208
  v_dot2c_f32_bf16 v29, s47, v209
  v_dot2c_f32_bf16 v31, v209, v209
  buffer_load_dwordx4 v6, s[20:23], s13 offen lds
  v_dot2c_f32_bf16 v29, s47, v210
  v_dot2c_f32_bf16 v31, v210, v210
  v_dot2c_f32_bf16 v29, s47, v211
  v_dot2c_f32_bf16 v31, v211, v211
  s_waitcnt vmcnt(11)
  v_dot2c_f32_bf16 v29, s47, v212
  v_dot2c_f32_bf16 v31, v212, v212
  v_dot2c_f32_bf16 v29, s47, v213
  v_dot2c_f32_bf16 v31, v213, v213
  v_dot2c_f32_bf16 v29, s47, v214
  v_dot2c_f32_bf16 v31, v214, v214
  v_dot2c_f32_bf16 v29, s47, v215
  v_dot2c_f32_bf16 v31, v215, v215
  v_lshlrev_b32 v216, 16, v196
  v_and_b32 v217, s46, v196
  v_add_f32_dpp v29, v29, v29 row_ror:8 row_mask:0xf bank_mask:0xf
  v_add_f32_dpp v31, v31, v31 row_ror:8 row_mask:0xf bank_mask:0xf
  v_lshlrev_b32 v218, 16, v197
  v_add_f32_dpp v29, v29, v29 row_ror:4 row_mask:0xf bank_mask:0xf
  v_add_f32_dpp v31, v31, v31 row_ror:4 row_mask:0xf bank_mask:0xf
  v_and_b32 v219, s46, v197
  v_add_f32_dpp v29, v29, v29 row_ror:2 row_mask:0xf bank_mask:0xf
  v_add_f32_dpp v31, v31, v31 row_ror:2 row_mask:0xf bank_mask:0xf
  s_nop 0
  v_add_f32_dpp v29, v29, v29 row_ror:1 row_mask:0xf bank_mask:0xf
  v_add_f32_dpp v31, v31, v31 row_ror:1 row_mask:0xf bank_mask:0xf
  v_mul_f32 v28, v29, v29
  v_fma_f32 v30, v29, v29, -v28
  v_fma_f32 v31, v31, s52, -v28
  v_sub_f32 v31, v31, v30
  v_max_f32 v31, 0, v31
  v_add_f32 v31, s53, v31
  v_rsq_f32 v31, v31
  buffer_load_dwordx4 v6, s[20:23], s37 offen offset:1024 lds
  s_add_u32 s37, s13, 3072
  v_mul_f32 v28, s52, v31
  v_fma_f32 v30, -v29, v31, 0
  v_pk_fma_f32 v[216:217], v[216:217], v[28:29], v[30:31] op_sel_hi:[1,0,0]
  v_pk_fma_f32 v[218:219], v[218:219], v[28:29], v[30:31] op_sel_hi:[1,0,0]
  v_pk_fma_f32 v[216:217], v[216:217], v[116:117], v[124:125]
  v_pk_fma_f32 v[218:219], v[218:219], v[118:119], v[126:127]
  v_cvt_pk_bf16_f32 v196, v216, v217
  v_cvt_pk_bf16_f32 v197, v218, v219
  v_lshlrev_b32 v220, 16, v198
  v_and_b32 v221, s46, v198
  v_lshlrev_b32 v222, 16, v199
  v_and_b32 v223, s46, v199
  v_pk_fma_f32 v[220:221], v[220:221], v[28:29], v[30:31] op_sel_hi:[1,0,0]
  v_pk_fma_f32 v[222:223], v[222:223], v[28:29], v[30:31] op_sel_hi:[1,0,0]
  v_pk_fma_f32 v[220:221], v[220:221], v[120:121], v[128:129]
  v_pk_fma_f32 v[222:223], v[222:223], v[122:123], v[130:131]
  v_cvt_pk_bf16_f32 v198, v220, v221
  v_cvt_pk_bf16_f32 v199, v222, v223
  ds_write_b128 v2, v[196:199] offset:20992
  v_lshlrev_b32 v224, 16, v200
  v_and_b32 v225, s46, v200
  v_lshlrev_b32 v226, 16, v201
  v_and_b32 v227, s46, v201
  v_pk_fma_f32 v[224:225], v[224:225], v[28:29], v[30:31] op_sel_hi:[1,0,0]
  v_pk_fma_f32 v[226:227], v[226:227], v[28:29], v[30:31] op_sel_hi:[1,0,0]
  v_pk_fma_f32 v[224:225], v[224:225], v[132:133], v[140:141]
  v_pk_fma_f32 v[226:227], v[226:227], v[134:135], v[142:143]
  buffer_load_dwordx4 v6, s[20:23], s37 offen offset:2048 lds
  s_add_u32 s37, s13, 22528
  v_cvt_pk_bf16_f32 v200, v224, v225
  v_cvt_pk_bf16_f32 v201, v226, v227
  v_lshlrev_b32 v228, 16, v202
  v_and_b32 v229, s46, v202
  v_lshlrev_b32 v230, 16, v203
  v_and_b32 v231, s46, v203
  v_pk_fma_f32 v[228:229], v[228:229], v[28:29], v[30:31] op_sel_hi:[1,0,0]
  v_pk_fma_f32 v[230:231], v[230:231], v[28:29], v[30:31] op_sel_hi:[1,0,0]
  v_pk_fma_f32 v[228:229], v[228:229], v[136:137], v[144:145]
  v_pk_fma_f32 v[230:231], v[230:231], v[138:139], v[146:147]
  v_cvt_pk_bf16_f32 v202, v228, v229
  v_cvt_pk_bf16_f32 v203, v230, v231
  ds_write_b128 v2, v[200:203] offset:21248
  v_lshlrev_b32 v232, 16, v204
  v_and_b32 v233, s46, v204
  v_lshlrev_b32 v234, 16, v205
  v_and_b32 v235, s46, v205
  v_pk_fma_f32 v[232:233], v[232:233], v[28:29], v[30:31] op_sel_hi:[1,0,0]
  v_pk_fma_f32 v[234:235], v[234:235], v[28:29], v[30:31] op_sel_hi:[1,0,0]
  v_pk_fma_f32 v[232:233], v[232:233], v[148:149], v[156:157]
  v_pk_fma_f32 v[234:235], v[234:235], v[150:151], v[158:159]
  v_cvt_pk_bf16_f32 v204, v232, v233
  v_cvt_pk_bf16_f32 v205, v234, v235
  v_lshlrev_b32 v216, 16, v206
  v_and_b32 v217, s46, v206
  v_lshlrev_b32 v218, 16, v207
  v_and_b32 v219, s46, v207
  v_pk_fma_f32 v[216:217], v[216:217], v[28:29], v[30:31] op_sel_hi:[1,0,0]
  v_pk_fma_f32 v[218:219], v[218:219], v[28:29], v[30:31] op_sel_hi:[1,0,0]
  v_pk_fma_f32 v[216:217], v[216:217], v[152:153], v[160:161]
  v_pk_fma_f32 v[218:219], v[218:219], v[154:155], v[162:163]
  v_cvt_pk_bf16_f32 v206, v216, v217
  v_cvt_pk_bf16_f32 v207, v218, v219
  ds_write_b128 v2, v[204:207] offset:21504
  v_lshlrev_b32 v220, 16, v208
  v_and_b32 v221, s46, v208
  v_lshlrev_b32 v222, 16, v209
  v_and_b32 v223, s46, v209
  v_pk_fma_f32 v[220:221], v[220:221], v[28:29], v[30:31] op_sel_hi:[1,0,0]
  v_pk_fma_f32 v[222:223], v[222:223], v[28:29], v[30:31] op_sel_hi:[1,0,0]
  v_pk_fma_f32 v[220:221], v[220:221], v[164:165], v[172:173]
  v_pk_fma_f32 v[222:223], v[222:223], v[166:167], v[174:175]
  v_cvt_pk_bf16_f32 v208, v220, v221
  v_cvt_pk_bf16_f32 v209, v222, v223
  v_lshlrev_b32 v224, 16, v210
  v_and_b32 v225, s46, v210
  v_lshlrev_b32 v226, 16, v211
  v_and_b32 v227, s46, v211
  v_pk_fma_f32 v[224:225], v[224:225], v[28:29], v[30:31] op_sel_hi:[1,0,0]
  v_pk_fma_f32 v[226:227], v[226:227], v[28:29], v[30:31] op_sel_hi:[1,0,0]
  v_pk_fma_f32 v[224:225], v[224:225], v[168:169], v[176:177]
  v_pk_fma_f32 v[226:227], v[226:227], v[170:171], v[178:179]
  v_cvt_pk_bf16_f32 v210, v224, v225
  v_cvt_pk_bf16_f32 v211, v226, v227
  ds_write_b128 v2, v[208:211] offset:21760
  buffer_load_dwordx4 v6, s[20:23], s37 offen offset:3072 lds
  s_add_u32 m0, s42, 4096
  v_lshlrev_b32 v228, 16, v212
  v_and_b32 v229, s46, v212
  v_lshlrev_b32 v230, 16, v213
  v_and_b32 v231, s46, v213
  v_pk_fma_f32 v[228:229], v[228:229], v[28:29], v[30:31] op_sel_hi:[1,0,0]
  v_pk_fma_f32 v[230:231], v[230:231], v[28:29], v[30:31] op_sel_hi:[1,0,0]
  v_pk_fma_f32 v[228:229], v[228:229], v[180:181], v[188:189]
  v_pk_fma_f32 v[230:231], v[230:231], v[182:183], v[190:191]
  v_cvt_pk_bf16_f32 v212, v228, v229
  v_cvt_pk_bf16_f32 v213, v230, v231
  v_lshlrev_b32 v232, 16, v214
  v_and_b32 v233, s46, v214
  buffer_load_dwordx4 v7, s[20:23], s13 offen lds
  s_add_u32 m0, s42, 20992
  s_add_u32 s13, s33, s11
  s_add_u32 s37, s13, 19456
  v_lshlrev_b32 v234, 16, v215
  v_and_b32 v235, s46, v215
  v_pk_fma_f32 v[232:233], v[232:233], v[28:29], v[30:31] op_sel_hi:[1,0,0]
  v_pk_fma_f32 v[234:235], v[234:235], v[28:29], v[30:31] op_sel_hi:[1,0,0]
  v_pk_fma_f32 v[232:233], v[232:233], v[184:185], v[192:193]
  v_pk_fma_f32 v[234:235], v[234:235], v[186:187], v[194:195]
  v_cvt_pk_bf16_f32 v214, v232, v233
  v_cvt_pk_bf16_f32 v215, v234, v235
  ds_write_b128 v2, v[212:215] offset:22016
  s_waitcnt vmcnt(8)
  ds_read_b64_tr_b16 a[0:1], v11 offset:20992
  ds_read_b64_tr_b16 a[4:5], v12 offset:20992
  ds_read_b64_tr_b16 a[8:9], v13 offset:20992
  ds_read_b64_tr_b16 a[12:13], v14 offset:20992
  v_mov_b32 v29, 0
  v_mov_b32 v31, 0
  v_dot2c_f32_bf16 v29, s47, v236
  v_dot2c_f32_bf16 v31, v236, v236
  v_dot2c_f32_bf16 v29, s47, v237
  v_dot2c_f32_bf16 v31, v237, v237
  v_dot2c_f32_bf16 v29, s47, v238
  v_dot2c_f32_bf16 v31, v238, v238
  v_dot2c_f32_bf16 v29, s47, v239
  v_dot2c_f32_bf16 v31, v239, v239
  v_dot2c_f32_bf16 v29, s47, v240
  v_dot2c_f32_bf16 v31, v240, v240
  v_dot2c_f32_bf16 v29, s47, v241
  v_dot2c_f32_bf16 v31, v241, v241
  v_dot2c_f32_bf16 v29, s47, v242
  v_dot2c_f32_bf16 v31, v242, v242
  v_dot2c_f32_bf16 v29, s47, v243
  v_dot2c_f32_bf16 v31, v243, v243
  v_dot2c_f32_bf16 v29, s47, v244
  v_dot2c_f32_bf16 v31, v244, v244
  v_dot2c_f32_bf16 v29, s47, v245
  v_dot2c_f32_bf16 v31, v245, v245
  v_dot2c_f32_bf16 v29, s47, v246
  v_dot2c_f32_bf16 v31, v246, v246
  v_dot2c_f32_bf16 v29, s47, v247
  v_dot2c_f32_bf16 v31, v247, v247
  v_dot2c_f32_bf16 v29, s47, v248
  s_waitcnt lgkmcnt(0)
  buffer_load_dwordx4 v6, s[20:23], s13 offen lds
  buffer_load_dwordx4 v6, s[20:23], s37 offen offset:1024 lds
  s_add_u32 s37, s13, 3072
  s_waitcnt vmcnt(8)
  ds_read_b64_tr_b16 a[2:3], v11 offset:23040
  ds_read_b64_tr_b16 a[6:7], v12 offset:23040
  ds_read_b64_tr_b16 a[10:11], v13 offset:23040
  ds_read_b64_tr_b16 a[14:15], v14 offset:23040
  v_dot2c_f32_bf16 v31, v248, v248
  v_dot2c_f32_bf16 v29, s47, v249
  v_dot2c_f32_bf16 v31, v249, v249
  v_dot2c_f32_bf16 v29, s47, v250
  v_dot2c_f32_bf16 v31, v250, v250
  v_dot2c_f32_bf16 v29, s47, v251
  v_dot2c_f32_bf16 v31, v251, v251
  v_dot2c_f32_bf16 v29, s47, v252
  v_dot2c_f32_bf16 v31, v252, v252
  v_dot2c_f32_bf16 v29, s47, v253
  v_dot2c_f32_bf16 v31, v253, v253
  v_dot2c_f32_bf16 v29, s47, v254
  v_dot2c_f32_bf16 v31, v254, v254
  v_dot2c_f32_bf16 v29, s47, v255
  v_dot2c_f32_bf16 v31, v255, v255
  v_lshlrev_b32 v216, 16, v236
  v_and_b32 v217, s46, v236
  v_add_f32_dpp v29, v29, v29 row_ror:8 row_mask:0xf bank_mask:0xf
  v_add_f32_dpp v31, v31, v31 row_ror:8 row_mask:0xf bank_mask:0xf
  s_nop 0
  v_add_f32_dpp v29, v29, v29 row_ror:4 row_mask:0xf bank_mask:0xf
  v_lshlrev_b32 v218, 16, v237
  s_waitcnt lgkmcnt(3)
  v_mfma_f32_16x16x32_bf16 v[32:35], a[0:3], v[16:19], 0
  v_add_f32_dpp v31, v31, v31 row_ror:4 row_mask:0xf bank_mask:0xf
  v_add_f32_dpp v29, v29, v29 row_ror:2 row_mask:0xf bank_mask:0xf
  s_waitcnt lgkmcnt(2)
  v_mfma_f32_16x16x32_bf16 v[36:39], a[4:7], v[16:19], 0
  s_waitcnt vmcnt(7)
  ds_read_b64_tr_b16 a[16:17], v15 offset:20992
  ds_read_b64_tr_b16 a[18:19], v15 offset:21120
  s_waitcnt lgkmcnt(3)
  v_mfma_f32_16x16x32_bf16 v[40:43], a[8:11], v[16:19], 0
  s_waitcnt lgkmcnt(2)
  buffer_load_dwordx4 v6, s[20:23], s37 offen offset:2048 lds
  s_add_u32 s37, s13, 22528
  v_mfma_f32_16x16x32_bf16 v[44:47], a[12:15], v[16:19], 0
  buffer_load_dwordx4 v6, s[20:23], s37 offen offset:3072 lds
  s_add_u32 m0, s42, 25088
  v_add_f32_dpp v31, v31, v31 row_ror:2 row_mask:0xf bank_mask:0xf
  v_add_f32_dpp v29, v29, v29 row_ror:1 row_mask:0xf bank_mask:0xf
  v_mul_f32 v28, v29, v29
  v_add_f32_dpp v31, v31, v31 row_ror:1 row_mask:0xf bank_mask:0xf
  v_fma_f32 v30, v29, v29, -v28
  v_fma_f32 v31, v31, s52, -v28
  v_sub_f32 v31, v31, v30
  v_max_f32 v31, 0, v31
  v_add_f32 v31, s53, v31
  v_rsq_f32 v31, v31
  s_nop 0
  v_mul_f32 v28, s52, v31
  v_fma_f32 v30, -v29, v31, 0
  v_and_b32 v219, s46, v237
  v_fma_f32 v216, v216, v28, v30
  v_fma_f32 v217, v217, v28, v30
  v_fma_f32 v218, v218, v28, v30
  v_fma_f32 v219, v219, v28, v30
  v_fma_f32 v216, v216, v116, v124
  s_waitcnt lgkmcnt(0)
  v_mfma_f32_16x16x32_bf16 v[48:51], a[16:19], v[16:19], 0
  ds_read_b128 v[16:19], v3 offset:62976
  s_waitcnt vmcnt(7)
  ds_read_b64_tr_b16 a[20:21], v11
  v_mfma_f32_16x16x32_bf16 v[52:55], a[0:3], v[20:23], 0
  ds_read_b64_tr_b16 a[24:25], v12
  ds_read_b64_tr_b16 a[28:29], v13
  v_mfma_f32_16x16x32_bf16 v[56:59], a[4:7], v[20:23], 0
  ds_read_b64_tr_b16 a[32:33], v14
  buffer_load_dwordx4 v7, s[20:23], s13 offen lds
  v_mfma_f32_16x16x32_bf16 v[60:63], a[8:11], v[20:23], 0
  s_add_u32 m0, s42, 0
  s_add_u32 s13, s33, s12
  s_add_u32 s37, s13, 19456
  v_mfma_f32_16x16x32_bf16 v[64:67], a[12:15], v[20:23], 0
  v_fma_f32 v217, v217, v117, v125
  v_fma_f32 v218, v218, v118, v126
  v_mfma_f32_16x16x32_bf16 v[68:71], a[16:19], v[20:23], 0
  ds_read_b128 v[20:23], v3 offset:64
  v_fma_f32 v219, v219, v119, v127
  v_mfma_f32_16x16x32_bf16 v[72:75], a[0:3], v[24:27], 0
  v_cvt_pk_bf16_f32 v236, v216, v217
  v_cvt_pk_bf16_f32 v237, v218, v219
  v_mfma_f32_16x16x32_bf16 v[76:79], a[4:7], v[24:27], 0
  v_lshlrev_b32 v220, 16, v238
  v_and_b32 v221, s46, v238
  v_mfma_f32_16x16x32_bf16 v[80:83], a[8:11], v[24:27], 0
  v_lshlrev_b32 v222, 16, v239
  v_and_b32 v223, s46, v239
  v_mfma_f32_16x16x32_bf16 v[84:87], a[12:15], v[24:27], 0
  s_waitcnt vmcnt(6)
  ds_read_b64_tr_b16 a[22:23], v11 offset:2048
  ds_read_b64_tr_b16 a[26:27], v12 offset:2048
  v_mfma_f32_16x16x32_bf16 v[88:91], a[16:19], v[24:27], 0
  ds_read_b128 v[24:27], v3 offset:21056
  ds_read_b64_tr_b16 a[30:31], v13 offset:2048
  s_waitcnt lgkmcnt(9)
  v_mfma_f32_16x16x32_bf16 v[92:95], a[0:3], v[16:19], 0
  ds_read_b64_tr_b16 a[34:35], v14 offset:2048
  s_waitcnt lgkmcnt(6)
  buffer_load_dwordx4 v6, s[20:23], s13 offen lds
  v_mfma_f32_16x16x32_bf16 v[96:99], a[4:7], v[16:19], 0
  buffer_load_dwordx4 v6, s[20:23], s37 offen offset:1024 lds
  s_add_u32 s37, s13, 3072
  v_mfma_f32_16x16x32_bf16 v[100:103], a[8:11], v[16:19], 0
  v_fma_f32 v220, v220, v28, v30
  v_fma_f32 v221, v221, v28, v30
  v_mfma_f32_16x16x32_bf16 v[104:107], a[12:15], v[16:19], 0
  s_waitcnt vmcnt(7)
  ds_read_b64_tr_b16 a[36:37], v15
  ds_read_b64_tr_b16 a[38:39], v15 offset:128
  v_mfma_f32_16x16x32_bf16 v[108:111], a[16:19], v[16:19], 0
  ds_read_b128 v[16:19], v3 offset:42048
  v_fma_f32 v222, v222, v28, v30
  s_waitcnt lgkmcnt(7)
  v_mfma_f32_16x16x32_bf16 v[32:35], a[20:23], v[20:23], v[32:35]
  v_fma_f32 v223, v223, v28, v30
  v_fma_f32 v220, v220, v120, v128
  s_waitcnt lgkmcnt(6)
  v_mfma_f32_16x16x32_bf16 v[36:39], a[24:27], v[20:23], v[36:39]
  v_fma_f32 v221, v221, v121, v129
  v_fma_f32 v222, v222, v122, v130
  s_waitcnt lgkmcnt(4)
  v_mfma_f32_16x16x32_bf16 v[40:43], a[28:31], v[20:23], v[40:43]
  s_waitcnt lgkmcnt(3)
  buffer_load_dwordx4 v6, s[20:23], s37 offen offset:2048 lds
  s_add_u32 s37, s13, 22528
  v_mfma_f32_16x16x32_bf16 v[44:47], a[32:35], v[20:23], v[44:47]
  buffer_load_dwordx4 v6, s[20:23], s37 offen offset:3072 lds
  s_add_u32 m0, s42, 4096
  v_fma_f32 v223, v223, v123, v131
  v_cvt_pk_bf16_f32 v238, v220, v221
  v_cvt_pk_bf16_f32 v239, v222, v223
  v_lshlrev_b32 v224, 16, v240
  v_and_b32 v225, s46, v240
  s_waitcnt lgkmcnt(1)
  v_mfma_f32_16x16x32_bf16 v[48:51], a[36:39], v[20:23], v[48:51]
  ds_read_b128 v[20:23], v3 offset:63040
  buffer_load_dwordx4 v7, s[20:23], s13 offen lds
  v_mfma_f32_16x16x32_bf16 v[52:55], a[20:23], v[24:27], v[52:55]
  s_add_u32 m0, s42, 20992
  s_waitcnt vmcnt(8)
  ds_read_b64_tr_b16 a[40:41], v11 offset:20992
  v_mfma_f32_16x16x32_bf16 v[56:59], a[24:27], v[24:27], v[56:59]
  s_add_u32 s13, s34, s9
  ds_read_b64_tr_b16 a[44:45], v12 offset:20992
  ds_read_b64_tr_b16 a[48:49], v13 offset:20992
  v_mfma_f32_16x16x32_bf16 v[60:63], a[28:31], v[24:27], v[60:63]
  s_add_u32 s37, s13, 19456
  ds_read_b64_tr_b16 a[52:53], v14 offset:20992
  v_lshlrev_b32 v226, 16, v241
  v_mfma_f32_16x16x32_bf16 v[64:67], a[32:35], v[24:27], v[64:67]
  v_and_b32 v227, s46, v241
  v_fma_f32 v224, v224, v28, v30
  v_mfma_f32_16x16x32_bf16 v[68:71], a[36:39], v[24:27], v[68:71]
  ds_read_b128 v[24:27], v3 offset:128
  v_fma_f32 v225, v225, v28, v30
  s_waitcnt lgkmcnt(6)
  v_mfma_f32_16x16x32_bf16 v[72:75], a[20:23], v[16:19], v[72:75]
  v_fma_f32 v226, v226, v28, v30
  v_fma_f32 v227, v227, v28, v30
  v_mfma_f32_16x16x32_bf16 v[76:79], a[24:27], v[16:19], v[76:79]
  v_fma_f32 v224, v224, v132, v140
  v_fma_f32 v225, v225, v133, v141
  v_mfma_f32_16x16x32_bf16 v[80:83], a[28:31], v[16:19], v[80:83]
  v_fma_f32 v226, v226, v134, v142
  v_fma_f32 v227, v227, v135, v143
  v_mfma_f32_16x16x32_bf16 v[84:87], a[32:35], v[16:19], v[84:87]
  s_waitcnt vmcnt(6)
  ds_read_b64_tr_b16 a[42:43], v11 offset:23040
  ds_read_b64_tr_b16 a[46:47], v12 offset:23040
  v_mfma_f32_16x16x32_bf16 v[88:91], a[36:39], v[16:19], v[88:91]
  ds_read_b128 v[16:19], v3 offset:21120
  ds_read_b64_tr_b16 a[50:51], v13 offset:23040
  s_waitcnt lgkmcnt(9)
  v_mfma_f32_16x16x32_bf16 v[92:95], a[20:23], v[20:23], v[92:95]
  ds_read_b64_tr_b16 a[54:55], v14 offset:23040
  s_waitcnt lgkmcnt(6)
  buffer_load_dwordx4 v6, s[20:23], s13 offen lds
  v_mfma_f32_16x16x32_bf16 v[96:99], a[24:27], v[20:23], v[96:99]
  buffer_load_dwordx4 v6, s[20:23], s37 offen offset:1024 lds
  s_add_u32 s37, s13, 3072
  v_mfma_f32_16x16x32_bf16 v[100:103], a[28:31], v[20:23], v[100:103]
  v_cvt_pk_bf16_f32 v240, v224, v225
  v_cvt_pk_bf16_f32 v241, v226, v227
  v_mfma_f32_16x16x32_bf16 v[104:107], a[32:35], v[20:23], v[104:107]
  s_waitcnt vmcnt(7)
  ds_read_b64_tr_b16 a[56:57], v15 offset:20992
  ds_read_b64_tr_b16 a[58:59], v15 offset:21120
  v_mfma_f32_16x16x32_bf16 v[108:111], a[36:39], v[20:23], v[108:111]
  ds_read_b128 v[20:23], v3 offset:42112
  v_lshlrev_b32 v228, 16, v242
  s_waitcnt lgkmcnt(7)
  v_mfma_f32_16x16x32_bf16 v[32:35], a[40:43], v[24:27], v[32:35]
  v_and_b32 v229, s46, v242
  v_lshlrev_b32 v230, 16, v243
  s_waitcnt lgkmcnt(6)
  v_mfma_f32_16x16x32_bf16 v[36:39], a[44:47], v[24:27], v[36:39]
  v_and_b32 v231, s46, v243
  v_fma_f32 v228, v228, v28, v30
  s_waitcnt lgkmcnt(4)
  v_mfma_f32_16x16x32_bf16 v[40:43], a[48:51], v[24:27], v[40:43]
  s_waitcnt lgkmcnt(3)
  buffer_load_dwordx4 v6, s[20:23], s37 offen offset:2048 lds
  s_add_u32 s37, s13, 22528
  v_mfma_f32_16x16x32_bf16 v[44:47], a[52:55], v[24:27], v[44:47]
  buffer_load_dwordx4 v6, s[20:23], s37 offen offset:3072 lds
  s_add_u32 m0, s42, 25088
  v_fma_f32 v229, v229, v28, v30
  v_fma_f32 v230, v230, v28, v30
  v_fma_f32 v231, v231, v28, v30
  v_fma_f32 v228, v228, v136, v144
  v_fma_f32 v229, v229, v137, v145
  s_waitcnt lgkmcnt(1)
  v_mfma_f32_16x16x32_bf16 v[48:51], a[56:59], v[24:27], v[48:51]
  ds_read_b128 v[24:27], v3 offset:63104
  buffer_load_dwordx4 v7, s[20:23], s13 offen lds
  v_mfma_f32_16x16x32_bf16 v[52:55], a[40:43], v[16:19], v[52:55]
  s_add_u32 m0, s42, 0
  s_waitcnt vmcnt(8)
  ds_read_b64_tr_b16 a[60:61], v11
  v_mfma_f32_16x16x32_bf16 v[56:59], a[44:47], v[16:19], v[56:59]
  s_add_u32 s13, s34, s10
  ds_read_b64_tr_b16 a[64:65], v12
  ds_read_b64_tr_b16 a[68:69], v13
  v_mfma_f32_16x16x32_bf16 v[60:63], a[48:51], v[16:19], v[60:63]
  s_add_u32 s37, s13, 19456
  ds_read_b64_tr_b16 a[72:73], v14
  v_fma_f32 v230, v230, v138, v146
  v_mfma_f32_16x16x32_bf16 v[64:67], a[52:55], v[16:19], v[64:67]
  v_fma_f32 v231, v231, v139, v147
  v_cvt_pk_bf16_f32 v242, v228, v229
  v_mfma_f32_16x16x32_bf16 v[68:71], a[56:59], v[16:19], v[68:71]
  ds_read_b128 v[16:19], v3 offset:192
  v_cvt_pk_bf16_f32 v243, v230, v231
  s_waitcnt lgkmcnt(6)
  v_mfma_f32_16x16x32_bf16 v[72:75], a[40:43], v[20:23], v[72:75]
  v_lshlrev_b32 v232, 16, v244
  v_and_b32 v233, s46, v244
  v_mfma_f32_16x16x32_bf16 v[76:79], a[44:47], v[20:23], v[76:79]
  v_lshlrev_b32 v234, 16, v245
  v_and_b32 v235, s46, v245
  v_mfma_f32_16x16x32_bf16 v[80:83], a[48:51], v[20:23], v[80:83]
  v_fma_f32 v232, v232, v28, v30
  v_fma_f32 v233, v233, v28, v30
  v_mfma_f32_16x16x32_bf16 v[84:87], a[52:55], v[20:23], v[84:87]
  s_waitcnt vmcnt(6)
  ds_read_b64_tr_b16 a[62:63], v11 offset:2048
  ds_read_b64_tr_b16 a[66:67], v12 offset:2048
  v_mfma_f32_16x16x32_bf16 v[88:91], a[56:59], v[20:23], v[88:91]
  ds_read_b128 v[20:23], v3 offset:21184
  ds_read_b64_tr_b16 a[70:71], v13 offset:2048
  s_waitcnt lgkmcnt(9)
  v_mfma_f32_16x16x32_bf16 v[92:95], a[40:43], v[24:27], v[92:95]
  ds_read_b64_tr_b16 a[74:75], v14 offset:2048
  s_waitcnt lgkmcnt(6)
  buffer_load_dwordx4 v6, s[20:23], s13 offen lds
  v_mfma_f32_16x16x32_bf16 v[96:99], a[44:47], v[24:27], v[96:99]
  buffer_load_dwordx4 v6, s[20:23], s37 offen offset:1024 lds
  s_add_u32 s37, s13, 3072
  v_mfma_f32_16x16x32_bf16 v[100:103], a[48:51], v[24:27], v[100:103]
  v_fma_f32 v234, v234, v28, v30
  v_fma_f32 v235, v235, v28, v30
  v_mfma_f32_16x16x32_bf16 v[104:107], a[52:55], v[24:27], v[104:107]
  v_fma_f32 v232, v232, v148, v156
  s_waitcnt vmcnt(7)
  ds_read_b64_tr_b16 a[76:77], v15
  v_mfma_f32_16x16x32_bf16 v[108:111], a[56:59], v[24:27], v[108:111]
  ds_read_b128 v[24:27], v3 offset:42176
  ds_read_b64_tr_b16 a[78:79], v15 offset:128
  s_waitcnt lgkmcnt(7)
  v_mfma_f32_16x16x32_bf16 v[32:35], a[60:63], v[16:19], v[32:35]
  v_fma_f32 v233, v233, v149, v157
  v_fma_f32 v234, v234, v150, v158
  s_waitcnt lgkmcnt(6)
  v_mfma_f32_16x16x32_bf16 v[36:39], a[64:67], v[16:19], v[36:39]
  v_fma_f32 v235, v235, v151, v159
  s_waitcnt lgkmcnt(3)
  buffer_load_dwordx4 v6, s[20:23], s37 offen offset:2048 lds
  v_mfma_f32_16x16x32_bf16 v[40:43], a[68:71], v[16:19], v[40:43]
  s_add_u32 s37, s13, 22528
  buffer_load_dwordx4 v6, s[20:23], s37 offen offset:3072 lds
  s_add_u32 m0, s42, 4096
  v_mfma_f32_16x16x32_bf16 v[44:47], a[72:75], v[16:19], v[44:47]
  v_cvt_pk_bf16_f32 v244, v232, v233
  v_cvt_pk_bf16_f32 v245, v234, v235
  v_lshlrev_b32 v216, 16, v246
  v_and_b32 v217, s46, v246
  v_lshlrev_b32 v218, 16, v247
  v_and_b32 v219, s46, v247
  v_fma_f32 v216, v216, v28, v30
  v_fma_f32 v217, v217, v28, v30
  v_fma_f32 v218, v218, v28, v30
  v_fma_f32 v219, v219, v28, v30
  v_fma_f32 v216, v216, v152, v160
  v_fma_f32 v217, v217, v153, v161
  s_waitcnt lgkmcnt(0)
  v_mfma_f32_16x16x32_bf16 v[48:51], a[76:79], v[16:19], v[48:51]
  ds_read_b128 v[16:19], v3 offset:63168
  s_waitcnt vmcnt(7)
  ds_read_b64_tr_b16 a[80:81], v11 offset:20992
  v_mfma_f32_16x16x32_bf16 v[52:55], a[60:63], v[20:23], v[52:55]
  ds_read_b64_tr_b16 a[84:85], v12 offset:20992
  ds_read_b64_tr_b16 a[88:89], v13 offset:20992
  v_mfma_f32_16x16x32_bf16 v[56:59], a[64:67], v[20:23], v[56:59]
  ds_read_b64_tr_b16 a[92:93], v14 offset:20992
  buffer_load_dwordx4 v7, s[20:23], s13 offen lds
  v_mfma_f32_16x16x32_bf16 v[60:63], a[68:71], v[20:23], v[60:63]
  s_add_u32 m0, s42, 20992
  s_add_u32 s13, s34, s11
  s_add_u32 s37, s13, 19456
  v_mfma_f32_16x16x32_bf16 v[64:67], a[72:75], v[20:23], v[64:67]
  v_fma_f32 v218, v218, v154, v162
  v_fma_f32 v219, v219, v155, v163
  v_mfma_f32_16x16x32_bf16 v[68:71], a[76:79], v[20:23], v[68:71]
  ds_read_b128 v[20:23], v3 offset:256
  v_cvt_pk_bf16_f32 v246, v216, v217
  v_mfma_f32_16x16x32_bf16 v[72:75], a[60:63], v[24:27], v[72:75]
  v_cvt_pk_bf16_f32 v247, v218, v219
  v_lshlrev_b32 v220, 16, v248
  v_mfma_f32_16x16x32_bf16 v[76:79], a[64:67], v[24:27], v[76:79]
  v_and_b32 v221, s46, v248
  v_lshlrev_b32 v222, 16, v249
  v_mfma_f32_16x16x32_bf16 v[80:83], a[68:71], v[24:27], v[80:83]
  s_waitcnt vmcnt(6)
  ds_read_b64_tr_b16 a[82:83], v11 offset:23040
  ds_read_b64_tr_b16 a[86:87], v12 offset:23040
  v_mfma_f32_16x16x32_bf16 v[84:87], a[72:75], v[24:27], v[84:87]
  ds_read_b64_tr_b16 a[90:91], v13 offset:23040
  ds_read_b64_tr_b16 a[94:95], v14 offset:23040
  v_mfma_f32_16x16x32_bf16 v[88:91], a[76:79], v[24:27], v[88:91]
  ds_read_b128 v[24:27], v3 offset:21248
  s_waitcnt lgkmcnt(6)
  buffer_load_dwordx4 v6, s[20:23], s13 offen lds
  v_mfma_f32_16x16x32_bf16 v[92:95], a[60:63], v[16:19], v[92:95]
  buffer_load_dwordx4 v6, s[20:23], s37 offen offset:1024 lds
  s_add_u32 s37, s13, 3072
  v_mfma_f32_16x16x32_bf16 v[96:99], a[64:67], v[16:19], v[96:99]
  v_and_b32 v223, s46, v249
  v_fma_f32 v220, v220, v28, v30
  v_mfma_f32_16x16x32_bf16 v[100:103], a[68:71], v[16:19], v[100:103]
  s_waitcnt vmcnt(7)
  ds_read_b64_tr_b16 a[96:97], v15 offset:20992
  ds_read_b64_tr_b16 a[98:99], v15 offset:21120
  v_mfma_f32_16x16x32_bf16 v[104:107], a[72:75], v[16:19], v[104:107]
  v_fma_f32 v221, v221, v28, v30
  v_fma_f32 v222, v222, v28, v30
  v_mfma_f32_16x16x32_bf16 v[108:111], a[76:79], v[16:19], v[108:111]
  ds_read_b128 v[16:19], v3 offset:42240
  v_fma_f32 v223, v223, v28, v30
  s_waitcnt lgkmcnt(7)
  v_mfma_f32_16x16x32_bf16 v[32:35], a[80:83], v[20:23], v[32:35]
  s_waitcnt lgkmcnt(4)
  buffer_load_dwordx4 v6, s[20:23], s37 offen offset:2048 lds
  s_add_u32 s37, s13, 22528
  v_mfma_f32_16x16x32_bf16 v[36:39], a[84:87], v[20:23], v[36:39]
  buffer_load_dwordx4 v6, s[20:23], s37 offen offset:3072 lds
  s_add_u32 m0, s42, 25088
  v_mfma_f32_16x16x32_bf16 v[40:43], a[88:91], v[20:23], v[40:43]
  v_fma_f32 v220, v220, v164, v172
  v_fma_f32 v221, v221, v165, v173
  v_mfma_f32_16x16x32_bf16 v[44:47], a[92:95], v[20:23], v[44:47]
  v_fma_f32 v222, v222, v166, v174
  v_fma_f32 v223, v223, v167, v175
  v_cvt_pk_bf16_f32 v248, v220, v221
  v_cvt_pk_bf16_f32 v249, v222, v223
  v_lshlrev_b32 v224, 16, v250
  s_waitcnt lgkmcnt(1)
  v_mfma_f32_16x16x32_bf16 v[48:51], a[96:99], v[20:23], v[48:51]
  ds_read_b128 v[20:23], v3 offset:63232
  buffer_load_dwordx4 v7, s[20:23], s13 offen lds
  v_mfma_f32_16x16x32_bf16 v[52:55], a[80:83], v[24:27], v[52:55]
  s_add_u32 m0, s42, 0
  s_waitcnt vmcnt(8)
  ds_read_b64_tr_b16 a[100:101], v11
  v_mfma_f32_16x16x32_bf16 v[56:59], a[84:87], v[24:27], v[56:59]
  s_add_u32 s13, s34, s12
  ds_read_b64_tr_b16 a[104:105], v12
  ds_read_b64_tr_b16 a[108:109], v13
  v_mfma_f32_16x16x32_bf16 v[60:63], a[88:91], v[24:27], v[60:63]
  s_add_u32 s37, s13, 19456
  ds_read_b64_tr_b16 a[112:113], v14
  v_and_b32 v225, s46, v250
  v_mfma_f32_16x16x32_bf16 v[64:67], a[92:95], v[24:27], v[64:67]
  v_lshlrev_b32 v226, 16, v251
  v_and_b32 v227, s46, v251
  v_mfma_f32_16x16x32_bf16 v[68:71], a[96:99], v[24:27], v[68:71]
  ds_read_b128 v[24:27], v3 offset:320
  v_fma_f32 v224, v224, v28, v30
  s_waitcnt lgkmcnt(6)
  v_mfma_f32_16x16x32_bf16 v[72:75], a[80:83], v[16:19], v[72:75]
  v_fma_f32 v225, v225, v28, v30
  v_fma_f32 v226, v226, v28, v30
  v_mfma_f32_16x16x32_bf16 v[76:79], a[84:87], v[16:19], v[76:79]
  v_fma_f32 v227, v227, v28, v30
  v_fma_f32 v224, v224, v168, v176
  v_mfma_f32_16x16x32_bf16 v[80:83], a[88:91], v[16:19], v[80:83]
  v_fma_f32 v225, v225, v169, v177
  v_fma_f32 v226, v226, v170, v178
  v_mfma_f32_16x16x32_bf16 v[84:87], a[92:95], v[16:19], v[84:87]
  s_waitcnt vmcnt(6)
  ds_read_b64_tr_b16 a[102:103], v11 offset:2048
  ds_read_b64_tr_b16 a[106:107], v12 offset:2048
  v_mfma_f32_16x16x32_bf16 v[88:91], a[96:99], v[16:19], v[88:91]
  ds_read_b128 v[16:19], v3 offset:21312
  ds_read_b64_tr_b16 a[110:111], v13 offset:2048
  s_waitcnt lgkmcnt(9)
  v_mfma_f32_16x16x32_bf16 v[92:95], a[80:83], v[20:23], v[92:95]
  ds_read_b64_tr_b16 a[114:115], v14 offset:2048
  s_waitcnt lgkmcnt(6)
  buffer_load_dwordx4 v6, s[20:23], s13 offen lds
  v_mfma_f32_16x16x32_bf16 v[96:99], a[84:87], v[20:23], v[96:99]
  buffer_load_dwordx4 v6, s[20:23], s37 offen offset:1024 lds
  s_add_u32 s37, s13, 3072
  v_mfma_f32_16x16x32_bf16 v[100:103], a[88:91], v[20:23], v[100:103]
  v_fma_f32 v227, v227, v171, v179
  v_cvt_pk_bf16_f32 v250, v224, v225
  v_mfma_f32_16x16x32_bf16 v[104:107], a[92:95], v[20:23], v[104:107]
  v_cvt_pk_bf16_f32 v251, v226, v227
  s_waitcnt vmcnt(7)
  ds_read_b64_tr_b16 a[116:117], v15
  v_mfma_f32_16x16x32_bf16 v[108:111], a[96:99], v[20:23], v[108:111]
  ds_read_b128 v[20:23], v3 offset:42304
  ds_read_b64_tr_b16 a[118:119], v15 offset:128
  s_waitcnt lgkmcnt(7)
  v_mfma_f32_16x16x32_bf16 v[32:35], a[100:103], v[24:27], v[32:35]
  v_lshlrev_b32 v228, 16, v252
  v_and_b32 v229, s46, v252
  s_waitcnt lgkmcnt(6)
  v_mfma_f32_16x16x32_bf16 v[36:39], a[104:107], v[24:27], v[36:39]
  v_lshlrev_b32 v230, 16, v253
  s_waitcnt lgkmcnt(3)
  buffer_load_dwordx4 v6, s[20:23], s37 offen offset:2048 lds
  v_mfma_f32_16x16x32_bf16 v[40:43], a[108:111], v[24:27], v[40:43]
  s_add_u32 s37, s13, 22528
  buffer_load_dwordx4 v6, s[20:23], s37 offen offset:3072 lds
  s_add_u32 m0, s42, 4096
  v_mfma_f32_16x16x32_bf16 v[44:47], a[112:115], v[24:27], v[44:47]
  v_and_b32 v231, s46, v253
  v_fma_f32 v228, v228, v28, v30
  v_fma_f32 v229, v229, v28, v30
  v_fma_f32 v230, v230, v28, v30
  v_fma_f32 v231, v231, v28, v30
  v_fma_f32 v228, v228, v180, v188
  v_fma_f32 v229, v229, v181, v189
  v_fma_f32 v230, v230, v182, v190
  v_fma_f32 v231, v231, v183, v191
  v_cvt_pk_bf16_f32 v252, v228, v229
  v_cvt_pk_bf16_f32 v253, v230, v231
  v_lshlrev_b32 v232, 16, v254
  s_waitcnt lgkmcnt(0)
  v_mfma_f32_16x16x32_bf16 v[48:51], a[116:119], v[24:27], v[48:51]
  ds_read_b128 v[24:27], v3 offset:63296
  s_waitcnt vmcnt(7)
  ds_read_b64_tr_b16 a[120:121], v11 offset:20992
  v_mfma_f32_16x16x32_bf16 v[52:55], a[100:103], v[16:19], v[52:55]
  ds_read_b64_tr_b16 a[124:125], v12 offset:20992
  ds_read_b64_tr_b16 a[128:129], v13 offset:20992
  v_mfma_f32_16x16x32_bf16 v[56:59], a[104:107], v[16:19], v[56:59]
  ds_read_b64_tr_b16 a[132:133], v14 offset:20992
  buffer_load_dwordx4 v7, s[20:23], s13 offen lds
  v_mfma_f32_16x16x32_bf16 v[60:63], a[108:111], v[16:19], v[60:63]
  s_add_u32 m0, s42, 20992
  s_add_u32 s13, s35, s9
  s_add_u32 s37, s13, 19456
  v_mfma_f32_16x16x32_bf16 v[64:67], a[112:115], v[16:19], v[64:67]
  v_and_b32 v233, s46, v254
  v_lshlrev_b32 v234, 16, v255
  v_mfma_f32_16x16x32_bf16 v[68:71], a[116:119], v[16:19], v[68:71]
  ds_read_b128 v[16:19], v3 offset:384
  v_and_b32 v235, s46, v255
  v_mfma_f32_16x16x32_bf16 v[72:75], a[100:103], v[20:23], v[72:75]
  v_fma_f32 v232, v232, v28, v30
  v_fma_f32 v233, v233, v28, v30
  v_mfma_f32_16x16x32_bf16 v[76:79], a[104:107], v[20:23], v[76:79]
  v_fma_f32 v234, v234, v28, v30
  v_fma_f32 v235, v235, v28, v30
  v_mfma_f32_16x16x32_bf16 v[80:83], a[108:111], v[20:23], v[80:83]
  s_waitcnt vmcnt(6)
  ds_read_b64_tr_b16 a[122:123], v11 offset:23040
  ds_read_b64_tr_b16 a[126:127], v12 offset:23040
  v_mfma_f32_16x16x32_bf16 v[84:87], a[112:115], v[20:23], v[84:87]
  ds_read_b64_tr_b16 a[130:131], v13 offset:23040
  ds_read_b64_tr_b16 a[134:135], v14 offset:23040
  v_mfma_f32_16x16x32_bf16 v[88:91], a[116:119], v[20:23], v[88:91]
  ds_read_b128 v[20:23], v3 offset:21376
  s_waitcnt lgkmcnt(6)
  buffer_load_dwordx4 v6, s[20:23], s13 offen lds
  v_mfma_f32_16x16x32_bf16 v[92:95], a[100:103], v[24:27], v[92:95]
  buffer_load_dwordx4 v6, s[20:23], s37 offen offset:1024 lds
  s_add_u32 s37, s13, 3072
  v_mfma_f32_16x16x32_bf16 v[96:99], a[104:107], v[24:27], v[96:99]
  v_fma_f32 v232, v232, v184, v192
  v_fma_f32 v233, v233, v185, v193
  v_mfma_f32_16x16x32_bf16 v[100:103], a[108:111], v[24:27], v[100:103]
  s_waitcnt vmcnt(7)
  ds_read_b64_tr_b16 a[136:137], v15 offset:20992
  ds_read_b64_tr_b16 a[138:139], v15 offset:21120
  v_mfma_f32_16x16x32_bf16 v[104:107], a[112:115], v[24:27], v[104:107]
  v_fma_f32 v234, v234, v186, v194
  v_fma_f32 v235, v235, v187, v195
  v_mfma_f32_16x16x32_bf16 v[108:111], a[116:119], v[24:27], v[108:111]
  ds_read_b128 v[24:27], v3 offset:42368
  v_cvt_pk_bf16_f32 v254, v232, v233
  s_waitcnt lgkmcnt(7)
  v_mfma_f32_16x16x32_bf16 v[32:35], a[120:123], v[16:19], v[32:35]
  s_waitcnt lgkmcnt(4)
  buffer_load_dwordx4 v6, s[20:23], s37 offen offset:2048 lds
  s_add_u32 s37, s13, 22528
  v_mfma_f32_16x16x32_bf16 v[36:39], a[124:127], v[16:19], v[36:39]
  buffer_load_dwordx4 v6, s[20:23], s37 offen offset:3072 lds
  s_add_u32 m0, s42, 25088
  v_mfma_f32_16x16x32_bf16 v[40:43], a[128:131], v[16:19], v[40:43]
  v_cvt_pk_bf16_f32 v255, v234, v235
  v_mbcnt_lo_u32_b32 v31, -1, 0
  v_mfma_f32_16x16x32_bf16 v[44:47], a[132:135], v[16:19], v[44:47]
  v_mbcnt_hi_u32_b32 v31, -1, v31
  v_lshrrev_b32 v29, 3, v31
  v_xor_b32 v30, v31, v29
  v_and_b32 v30, 7, v30
  v_lshlrev_b32 v30, 4, v30
  s_waitcnt lgkmcnt(1)
  v_mfma_f32_16x16x32_bf16 v[48:51], a[136:139], v[16:19], v[48:51]
  ds_read_b128 v[16:19], v3 offset:63360
  buffer_load_dwordx4 v7, s[20:23], s13 offen lds
  v_mfma_f32_16x16x32_bf16 v[52:55], a[120:123], v[20:23], v[52:55]
  s_add_u32 m0, s42, 0
  s_waitcnt vmcnt(8)
  ds_read_b64_tr_b16 a[140:141], v11
  v_mfma_f32_16x16x32_bf16 v[56:59], a[124:127], v[20:23], v[56:59]
  s_add_u32 s13, s35, s10
  ds_read_b64_tr_b16 a[144:145], v12
  ds_read_b64_tr_b16 a[148:149], v13
  v_mfma_f32_16x16x32_bf16 v[60:63], a[128:131], v[20:23], v[60:63]
  s_add_u32 s37, s13, 19456
  ds_read_b64_tr_b16 a[152:153], v14
  v_lshl_add_u32 v30, v29, 7, v30
  v_mfma_f32_16x16x32_bf16 v[64:67], a[132:135], v[20:23], v[64:67]
  v_add_u32 v28, s42, v30
  v_bfe_u32 v29, v31, 4, 1
  v_mfma_f32_16x16x32_bf16 v[68:71], a[136:139], v[20:23], v[68:71]
  ds_read_b128 v[20:23], v3 offset:448
  v_lshrrev_b32 v30, 5, v31
  s_waitcnt lgkmcnt(6)
  v_mfma_f32_16x16x32_bf16 v[72:75], a[120:123], v[24:27], v[72:75]
  v_lshl_add_u32 v29, v29, 1, v30
  v_xor_b32 v29, v29, v31
  v_mfma_f32_16x16x32_bf16 v[76:79], a[124:127], v[24:27], v[76:79]
  v_and_b32 v29, 7, v29
  v_lshlrev_b32 v29, 4, v29
  v_mfma_f32_16x16x32_bf16 v[80:83], a[128:131], v[24:27], v[80:83]
  v_and_b32 v31, 15, v31
  v_lshl_add_u32 v29, v31, 7, v29
  v_mfma_f32_16x16x32_bf16 v[84:87], a[132:135], v[24:27], v[84:87]
  s_waitcnt vmcnt(6)
  ds_read_b64_tr_b16 a[142:143], v11 offset:2048
  ds_read_b64_tr_b16 a[146:147], v12 offset:2048
  v_mfma_f32_16x16x32_bf16 v[88:91], a[136:139], v[24:27], v[88:91]
  ds_read_b128 v[24:27], v3 offset:21440
  ds_read_b64_tr_b16 a[150:151], v13 offset:2048
  s_waitcnt lgkmcnt(9)
  v_mfma_f32_16x16x32_bf16 v[92:95], a[120:123], v[16:19], v[92:95]
  ds_read_b64_tr_b16 a[154:155], v14 offset:2048
  s_waitcnt lgkmcnt(6)
  buffer_load_dwordx4 v6, s[20:23], s13 offen lds
  v_mfma_f32_16x16x32_bf16 v[96:99], a[124:127], v[16:19], v[96:99]
  buffer_load_dwordx4 v6, s[20:23], s37 offen offset:1024 lds
  s_add_u32 s37, s13, 3072
  v_mfma_f32_16x16x32_bf16 v[100:103], a[128:131], v[16:19], v[100:103]
  v_mov_b32 v31, 0
  v_add_u32 v29, s42, v29
  v_mfma_f32_16x16x32_bf16 v[104:107], a[132:135], v[16:19], v[104:107]
  s_waitcnt vmcnt(7)
  ds_read_b64_tr_b16 a[156:157], v15
  v_mfma_f32_16x16x32_bf16 v[108:111], a[136:139], v[16:19], v[108:111]
  ds_read_b128 v[16:19], v3 offset:42432
  ds_read_b64_tr_b16 a[158:159], v15 offset:128
  s_waitcnt lgkmcnt(7)
  v_mfma_f32_16x16x32_bf16 v[32:35], a[140:143], v[20:23], v[32:35]
  s_waitcnt lgkmcnt(6)
  v_mfma_f32_16x16x32_bf16 v[36:39], a[144:147], v[20:23], v[36:39]
  s_waitcnt lgkmcnt(4)
  v_mfma_f32_16x16x32_bf16 v[40:43], a[148:151], v[20:23], v[40:43]
  s_waitcnt lgkmcnt(3)
  buffer_load_dwordx4 v6, s[20:23], s37 offen offset:2048 lds
  s_add_u32 s37, s13, 22528
  v_mfma_f32_16x16x32_bf16 v[44:47], a[152:155], v[20:23], v[44:47]
  buffer_load_dwordx4 v6, s[20:23], s37 offen offset:3072 lds
  s_add_u32 m0, s42, 4096
  s_waitcnt lgkmcnt(0)
  v_mfma_f32_16x16x32_bf16 v[48:51], a[156:159], v[20:23], v[48:51]
  ds_read_b128 v[20:23], v3 offset:63424
  s_waitcnt vmcnt(7)
  ds_read_b64_tr_b16 a[160:161], v11 offset:20992
  v_mfma_f32_16x16x32_bf16 v[52:55], a[140:143], v[24:27], v[52:55]
  ds_read_b64_tr_b16 a[164:165], v12 offset:20992
  ds_read_b64_tr_b16 a[168:169], v13 offset:20992
  v_mfma_f32_16x16x32_bf16 v[56:59], a[144:147], v[24:27], v[56:59]
  ds_read_b64_tr_b16 a[172:173], v14 offset:20992
  buffer_load_dwordx4 v7, s[20:23], s13 offen lds
  v_mfma_f32_16x16x32_bf16 v[60:63], a[148:151], v[24:27], v[60:63]
  s_add_u32 m0, s42, 20992
  s_add_u32 s13, s35, s11
  s_add_u32 s37, s13, 19456
  v_mfma_f32_16x16x32_bf16 v[64:67], a[152:155], v[24:27], v[64:67]
  v_mfma_f32_16x16x32_bf16 v[68:71], a[156:159], v[24:27], v[68:71]
  ds_read_b128 v[24:27], v3 offset:512
  v_mfma_f32_16x16x32_bf16 v[72:75], a[140:143], v[16:19], v[72:75]
  v_mfma_f32_16x16x32_bf16 v[76:79], a[144:147], v[16:19], v[76:79]
  v_mfma_f32_16x16x32_bf16 v[80:83], a[148:151], v[16:19], v[80:83]
  s_waitcnt vmcnt(6)
  ds_read_b64_tr_b16 a[162:163], v11 offset:23040
  v_mfma_f32_16x16x32_bf16 v[84:87], a[152:155], v[16:19], v[84:87]
  ds_read_b64_tr_b16 a[166:167], v12 offset:23040
  ds_read_b64_tr_b16 a[170:171], v13 offset:23040
  v_mfma_f32_16x16x32_bf16 v[88:91], a[156:159], v[16:19], v[88:91]
  ds_read_b128 v[16:19], v3 offset:21504
  ds_read_b64_tr_b16 a[174:175], v14 offset:23040
  s_waitcnt lgkmcnt(10)
  v_mfma_f32_16x16x32_bf16 v[92:95], a[140:143], v[20:23], v[92:95]
  s_waitcnt lgkmcnt(6)
  buffer_load_dwordx4 v6, s[20:23], s13 offen lds
  buffer_load_dwordx4 v6, s[20:23], s37 offen offset:1024 lds
  v_mfma_f32_16x16x32_bf16 v[96:99], a[144:147], v[20:23], v[96:99]
  s_add_u32 s37, s13, 3072
  v_mfma_f32_16x16x32_bf16 v[100:103], a[148:151], v[20:23], v[100:103]
  v_mfma_f32_16x16x32_bf16 v[104:107], a[152:155], v[20:23], v[104:107]
  s_waitcnt vmcnt(7)
  ds_read_b64_tr_b16 a[176:177], v15 offset:20992
  ds_read_b64_tr_b16 a[178:179], v15 offset:21120
  v_mfma_f32_16x16x32_bf16 v[108:111], a[156:159], v[20:23], v[108:111]
  ds_read_b128 v[20:23], v3 offset:42496
  s_waitcnt lgkmcnt(7)
  v_mfma_f32_16x16x32_bf16 v[32:35], a[160:163], v[24:27], v[32:35]
  s_waitcnt lgkmcnt(6)
  v_mfma_f32_16x16x32_bf16 v[36:39], a[164:167], v[24:27], v[36:39]
  s_waitcnt lgkmcnt(5)
  v_mfma_f32_16x16x32_bf16 v[40:43], a[168:171], v[24:27], v[40:43]
  s_waitcnt lgkmcnt(3)
  buffer_load_dwordx4 v6, s[20:23], s37 offen offset:2048 lds
  s_add_u32 s37, s13, 22528
  v_mfma_f32_16x16x32_bf16 v[44:47], a[172:175], v[24:27], v[44:47]
  buffer_load_dwordx4 v6, s[20:23], s37 offen offset:3072 lds
  s_add_u32 m0, s42, 25088
  s_waitcnt lgkmcnt(1)
  v_mfma_f32_16x16x32_bf16 v[48:51], a[176:179], v[24:27], v[48:51]
  ds_read_b128 v[24:27], v3 offset:63488
  s_waitcnt vmcnt(7)
  ds_read_b64_tr_b16 a[180:181], v11
  v_mfma_f32_16x16x32_bf16 v[52:55], a[160:163], v[16:19], v[52:55]
  ds_read_b64_tr_b16 a[184:185], v12
  ds_read_b64_tr_b16 a[188:189], v13
  v_mfma_f32_16x16x32_bf16 v[56:59], a[164:167], v[16:19], v[56:59]
  ds_read_b64_tr_b16 a[192:193], v14
  buffer_load_dwordx4 v7, s[20:23], s13 offen lds
  v_mfma_f32_16x16x32_bf16 v[60:63], a[168:171], v[16:19], v[60:63]
  s_add_u32 m0, s42, 0
  s_add_u32 s13, s35, s12
  s_add_u32 s37, s13, 19456
  v_mfma_f32_16x16x32_bf16 v[64:67], a[172:175], v[16:19], v[64:67]
  v_mfma_f32_16x16x32_bf16 v[68:71], a[176:179], v[16:19], v[68:71]
  ds_read_b128 v[16:19], v3 offset:576
  s_waitcnt lgkmcnt(6)
  v_mfma_f32_16x16x32_bf16 v[72:75], a[160:163], v[20:23], v[72:75]
  v_mfma_f32_16x16x32_bf16 v[76:79], a[164:167], v[20:23], v[76:79]
  v_mfma_f32_16x16x32_bf16 v[80:83], a[168:171], v[20:23], v[80:83]
  v_mfma_f32_16x16x32_bf16 v[84:87], a[172:175], v[20:23], v[84:87]
  s_waitcnt vmcnt(6)
  ds_read_b64_tr_b16 a[182:183], v11 offset:2048
  ds_read_b64_tr_b16 a[186:187], v12 offset:2048
  v_mfma_f32_16x16x32_bf16 v[88:91], a[176:179], v[20:23], v[88:91]
  ds_read_b128 v[20:23], v3 offset:21568
  ds_read_b64_tr_b16 a[190:191], v13 offset:2048
  s_waitcnt lgkmcnt(9)
  v_mfma_f32_16x16x32_bf16 v[92:95], a[160:163], v[24:27], v[92:95]
  ds_read_b64_tr_b16 a[194:195], v14 offset:2048
  s_waitcnt lgkmcnt(6)
  buffer_load_dwordx4 v6, s[20:23], s13 offen lds
  v_mfma_f32_16x16x32_bf16 v[96:99], a[164:167], v[24:27], v[96:99]
  buffer_load_dwordx4 v6, s[20:23], s37 offen offset:1024 lds
  s_add_u32 s37, s13, 3072
  v_mfma_f32_16x16x32_bf16 v[100:103], a[168:171], v[24:27], v[100:103]
  v_mfma_f32_16x16x32_bf16 v[104:107], a[172:175], v[24:27], v[104:107]
  s_waitcnt vmcnt(7)
  ds_read_b64_tr_b16 a[196:197], v15
  ds_read_b64_tr_b16 a[198:199], v15 offset:128
  v_mfma_f32_16x16x32_bf16 v[108:111], a[176:179], v[24:27], v[108:111]
  ds_read_b128 v[24:27], v3 offset:42560
  s_waitcnt lgkmcnt(7)
  v_mfma_f32_16x16x32_bf16 v[32:35], a[180:183], v[16:19], v[32:35]
  s_waitcnt lgkmcnt(6)
  v_mfma_f32_16x16x32_bf16 v[36:39], a[184:187], v[16:19], v[36:39]
  s_waitcnt lgkmcnt(4)
  v_mfma_f32_16x16x32_bf16 v[40:43], a[188:191], v[16:19], v[40:43]
  s_waitcnt lgkmcnt(3)
  buffer_load_dwordx4 v6, s[20:23], s37 offen offset:2048 lds
  s_add_u32 s37, s13, 22528
  v_mfma_f32_16x16x32_bf16 v[44:47], a[192:195], v[16:19], v[44:47]
  buffer_load_dwordx4 v6, s[20:23], s37 offen offset:3072 lds
  s_add_u32 m0, s42, 4096
  s_waitcnt lgkmcnt(1)
  v_mfma_f32_16x16x32_bf16 v[48:51], a[196:199], v[16:19], v[48:51]
  ds_read_b128 v[16:19], v3 offset:63552
  buffer_load_dwordx4 v7, s[20:23], s13 offen lds
  v_mfma_f32_16x16x32_bf16 v[52:55], a[180:183], v[20:23], v[52:55]
  s_add_u32 m0, s42, 20992
  s_waitcnt vmcnt(8)
  ds_read_b64_tr_b16 a[200:201], v11 offset:20992
  v_mfma_f32_16x16x32_bf16 v[56:59], a[184:187], v[20:23], v[56:59]
  s_add_u32 s13, s38, s9
  ds_read_b64_tr_b16 a[204:205], v12 offset:20992
  ds_read_b64_tr_b16 a[208:209], v13 offset:20992
  v_mfma_f32_16x16x32_bf16 v[60:63], a[188:191], v[20:23], v[60:63]
  s_add_u32 s37, s13, 19456
  ds_read_b64_tr_b16 a[212:213], v14 offset:20992
  v_mfma_f32_16x16x32_bf16 v[64:67], a[192:195], v[20:23], v[64:67]
  v_mfma_f32_16x16x32_bf16 v[68:71], a[196:199], v[20:23], v[68:71]
  ds_read_b128 v[20:23], v3 offset:640
  s_waitcnt lgkmcnt(6)
  v_mfma_f32_16x16x32_bf16 v[72:75], a[180:183], v[24:27], v[72:75]
  v_mfma_f32_16x16x32_bf16 v[76:79], a[184:187], v[24:27], v[76:79]
  v_mfma_f32_16x16x32_bf16 v[80:83], a[188:191], v[24:27], v[80:83]
  v_mfma_f32_16x16x32_bf16 v[84:87], a[192:195], v[24:27], v[84:87]
  v_mfma_f32_16x16x32_bf16 v[88:91], a[196:199], v[24:27], v[88:91]
  ds_read_b128 v[24:27], v3 offset:21632
  s_waitcnt vmcnt(6)
  ds_read_b64_tr_b16 a[202:203], v11 offset:23040
  s_waitcnt lgkmcnt(7)
  v_mfma_f32_16x16x32_bf16 v[92:95], a[180:183], v[16:19], v[92:95]
  ds_read_b64_tr_b16 a[206:207], v12 offset:23040
  ds_read_b64_tr_b16 a[210:211], v13 offset:23040
  v_mfma_f32_16x16x32_bf16 v[96:99], a[184:187], v[16:19], v[96:99]
  ds_read_b64_tr_b16 a[214:215], v14 offset:23040
  s_waitcnt lgkmcnt(6)
  buffer_load_dwordx4 v6, s[20:23], s13 offen lds
  v_mfma_f32_16x16x32_bf16 v[100:103], a[188:191], v[16:19], v[100:103]
  buffer_load_dwordx4 v6, s[20:23], s37 offen offset:1024 lds
  s_add_u32 s37, s13, 3072
  v_mfma_f32_16x16x32_bf16 v[104:107], a[192:195], v[16:19], v[104:107]
  s_waitcnt vmcnt(7)
  ds_read_b64_tr_b16 a[216:217], v15 offset:20992
  v_mfma_f32_16x16x32_bf16 v[108:111], a[196:199], v[16:19], v[108:111]
  ds_read_b128 v[16:19], v3 offset:42624
  ds_read_b64_tr_b16 a[218:219], v15 offset:21120
  s_waitcnt lgkmcnt(6)
  v_mfma_f32_16x16x32_bf16 v[32:35], a[200:203], v[20:23], v[32:35]
  s_waitcnt lgkmcnt(5)
  v_mfma_f32_16x16x32_bf16 v[36:39], a[204:207], v[20:23], v[36:39]
  s_waitcnt lgkmcnt(4)
  v_mfma_f32_16x16x32_bf16 v[40:43], a[208:211], v[20:23], v[40:43]
  s_waitcnt lgkmcnt(3)
  buffer_load_dwordx4 v6, s[20:23], s37 offen offset:2048 lds
  s_add_u32 s37, s13, 22528
  v_mfma_f32_16x16x32_bf16 v[44:47], a[212:215], v[20:23], v[44:47]
  buffer_load_dwordx4 v6, s[20:23], s37 offen offset:3072 lds
  s_add_u32 m0, s42, 25088
  s_waitcnt lgkmcnt(0)
  v_mfma_f32_16x16x32_bf16 v[48:51], a[216:219], v[20:23], v[48:51]
  ds_read_b128 v[20:23], v3 offset:63616
  s_waitcnt vmcnt(7)
  ds_read_b64_tr_b16 a[220:221], v11
  v_mfma_f32_16x16x32_bf16 v[52:55], a[200:203], v[24:27], v[52:55]
  ds_read_b64_tr_b16 a[224:225], v12
  ds_read_b64_tr_b16 a[228:229], v13
  v_mfma_f32_16x16x32_bf16 v[56:59], a[204:207], v[24:27], v[56:59]
  ds_read_b64_tr_b16 a[232:233], v14
  buffer_load_dwordx4 v7, s[20:23], s13 offen lds
  v_mfma_f32_16x16x32_bf16 v[60:63], a[208:211], v[24:27], v[60:63]
  s_add_u32 m0, s42, 0
  s_add_u32 s13, s38, s10
  s_add_u32 s37, s13, 19456
  v_mfma_f32_16x16x32_bf16 v[64:67], a[212:215], v[24:27], v[64:67]
  v_mfma_f32_16x16x32_bf16 v[68:71], a[216:219], v[24:27], v[68:71]
  ds_read_b128 v[24:27], v3 offset:704
  v_mfma_f32_16x16x32_bf16 v[72:75], a[200:203], v[16:19], v[72:75]
  v_mfma_f32_16x16x32_bf16 v[76:79], a[204:207], v[16:19], v[76:79]
  v_mfma_f32_16x16x32_bf16 v[80:83], a[208:211], v[16:19], v[80:83]
  s_waitcnt vmcnt(6)
  ds_read_b64_tr_b16 a[222:223], v11 offset:2048
  v_mfma_f32_16x16x32_bf16 v[84:87], a[212:215], v[16:19], v[84:87]
  ds_read_b64_tr_b16 a[226:227], v12 offset:2048
  ds_read_b64_tr_b16 a[230:231], v13 offset:2048
  v_mfma_f32_16x16x32_bf16 v[88:91], a[216:219], v[16:19], v[88:91]
  ds_read_b128 v[16:19], v3 offset:21696
  ds_read_b64_tr_b16 a[234:235], v14 offset:2048
  s_waitcnt lgkmcnt(10)
  v_mfma_f32_16x16x32_bf16 v[92:95], a[200:203], v[20:23], v[92:95]
  s_waitcnt lgkmcnt(6)
  buffer_load_dwordx4 v6, s[20:23], s13 offen lds
  buffer_load_dwordx4 v6, s[20:23], s37 offen offset:1024 lds
  v_mfma_f32_16x16x32_bf16 v[96:99], a[204:207], v[20:23], v[96:99]
  s_add_u32 s37, s13, 3072
  v_mfma_f32_16x16x32_bf16 v[100:103], a[208:211], v[20:23], v[100:103]
  v_mfma_f32_16x16x32_bf16 v[104:107], a[212:215], v[20:23], v[104:107]
  s_waitcnt vmcnt(7)
  ds_read_b64_tr_b16 a[236:237], v15
  ds_read_b64_tr_b16 a[238:239], v15 offset:128
  v_mfma_f32_16x16x32_bf16 v[108:111], a[216:219], v[20:23], v[108:111]
  ds_read_b128 v[20:23], v3 offset:42688
  s_waitcnt lgkmcnt(7)
  v_mfma_f32_16x16x32_bf16 v[32:35], a[220:223], v[24:27], v[32:35]
  s_waitcnt lgkmcnt(6)
  v_mfma_f32_16x16x32_bf16 v[36:39], a[224:227], v[24:27], v[36:39]
  s_waitcnt lgkmcnt(5)
  v_mfma_f32_16x16x32_bf16 v[40:43], a[228:231], v[24:27], v[40:43]
  s_waitcnt lgkmcnt(3)
  buffer_load_dwordx4 v6, s[20:23], s37 offen offset:2048 lds
  s_add_u32 s37, s13, 22528
  v_mfma_f32_16x16x32_bf16 v[44:47], a[232:235], v[24:27], v[44:47]
  buffer_load_dwordx4 v6, s[20:23], s37 offen offset:3072 lds
  s_add_u32 m0, s42, 4096
  s_waitcnt lgkmcnt(1)
  v_mfma_f32_16x16x32_bf16 v[48:51], a[236:239], v[24:27], v[48:51]
  ds_read_b128 v[24:27], v3 offset:63680
  buffer_load_dwordx4 v7, s[20:23], s13 offen lds
  v_mfma_f32_16x16x32_bf16 v[52:55], a[220:223], v[16:19], v[52:55]
  s_add_u32 m0, s42, 20992
  s_waitcnt vmcnt(8)
  ds_read_b64_tr_b16 a[240:241], v11 offset:20992
  v_mfma_f32_16x16x32_bf16 v[56:59], a[224:227], v[16:19], v[56:59]
  s_add_u32 s13, s38, s11
  ds_read_b64_tr_b16 a[244:245], v12 offset:20992
  ds_read_b64_tr_b16 a[248:249], v13 offset:20992
  v_mfma_f32_16x16x32_bf16 v[60:63], a[228:231], v[16:19], v[60:63]
  s_add_u32 s37, s13, 19456
  ds_read_b64_tr_b16 a[252:253], v14 offset:20992
  v_mfma_f32_16x16x32_bf16 v[64:67], a[232:235], v[16:19], v[64:67]
  v_mfma_f32_16x16x32_bf16 v[68:71], a[236:239], v[16:19], v[68:71]
  ds_read_b128 v[16:19], v3 offset:768
  s_waitcnt lgkmcnt(6)
  v_mfma_f32_16x16x32_bf16 v[72:75], a[220:223], v[20:23], v[72:75]
  v_mfma_f32_16x16x32_bf16 v[76:79], a[224:227], v[20:23], v[76:79]
  v_mfma_f32_16x16x32_bf16 v[80:83], a[228:231], v[20:23], v[80:83]
  v_mfma_f32_16x16x32_bf16 v[84:87], a[232:235], v[20:23], v[84:87]
  s_waitcnt vmcnt(6)
  ds_read_b64_tr_b16 a[242:243], v11 offset:23040
  v_mfma_f32_16x16x32_bf16 v[88:91], a[236:239], v[20:23], v[88:91]
  ds_read_b128 v[20:23], v3 offset:21760
  ds_read_b64_tr_b16 a[246:247], v12 offset:23040
  s_waitcnt lgkmcnt(8)
  v_mfma_f32_16x16x32_bf16 v[92:95], a[220:223], v[24:27], v[92:95]
  ds_read_b64_tr_b16 a[250:251], v13 offset:23040
  ds_read_b64_tr_b16 a[254:255], v14 offset:23040
  v_mfma_f32_16x16x32_bf16 v[96:99], a[224:227], v[24:27], v[96:99]
  s_waitcnt lgkmcnt(6)
  buffer_load_dwordx4 v6, s[20:23], s13 offen lds
  buffer_load_dwordx4 v6, s[20:23], s37 offen offset:1024 lds
  v_mfma_f32_16x16x32_bf16 v[100:103], a[228:231], v[24:27], v[100:103]
  s_add_u32 s37, s13, 3072
  v_mfma_f32_16x16x32_bf16 v[104:107], a[232:235], v[24:27], v[104:107]
  v_mfma_f32_16x16x32_bf16 v[108:111], a[236:239], v[24:27], v[108:111]
  ds_read_b128 v[24:27], v3 offset:42752
  s_waitcnt vmcnt(7)
  ds_read_b64_tr_b16 v[112:113], v15 offset:20992
  ds_read_b64_tr_b16 v[114:115], v15 offset:21120
  s_waitcnt lgkmcnt(7)
  v_mfma_f32_16x16x32_bf16 v[32:35], a[240:243], v[16:19], v[32:35]
  s_waitcnt lgkmcnt(5)
  v_mfma_f32_16x16x32_bf16 v[36:39], a[244:247], v[16:19], v[36:39]
  s_waitcnt lgkmcnt(4)
  v_mfma_f32_16x16x32_bf16 v[40:43], a[248:251], v[16:19], v[40:43]
  s_waitcnt lgkmcnt(3)
  buffer_load_dwordx4 v6, s[20:23], s37 offen offset:2048 lds
  s_add_u32 s37, s13, 22528
  v_mfma_f32_16x16x32_bf16 v[44:47], a[252:255], v[16:19], v[44:47]
  buffer_load_dwordx4 v6, s[20:23], s37 offen offset:3072 lds
  s_add_u32 m0, s42, 25088
  s_waitcnt lgkmcnt(0)
  v_mfma_f32_16x16x32_bf16 v[48:51], v[112:115], v[16:19], v[48:51]
  ds_read_b128 v[16:19], v3 offset:63744
  s_waitcnt vmcnt(7)
  ds_read_b64_tr_b16 v[116:117], v11
  v_mfma_f32_16x16x32_bf16 v[52:55], a[240:243], v[20:23], v[52:55]
  ds_read_b64_tr_b16 v[120:121], v12
  ds_read_b64_tr_b16 v[124:125], v13
  v_mfma_f32_16x16x32_bf16 v[56:59], a[244:247], v[20:23], v[56:59]
  ds_read_b64_tr_b16 v[128:129], v14
  buffer_load_dwordx4 v7, s[20:23], s13 offen lds
  v_mfma_f32_16x16x32_bf16 v[60:63], a[248:251], v[20:23], v[60:63]
  s_add_u32 m0, s42, 0
  s_add_u32 s13, s38, s12
  s_add_u32 s37, s13, 19456
  v_mfma_f32_16x16x32_bf16 v[64:67], a[252:255], v[20:23], v[64:67]
  v_mfma_f32_16x16x32_bf16 v[68:71], v[112:115], v[20:23], v[68:71]
  ds_read_b128 v[20:23], v3 offset:832
  v_mfma_f32_16x16x32_bf16 v[72:75], a[240:243], v[24:27], v[72:75]
  v_mfma_f32_16x16x32_bf16 v[76:79], a[244:247], v[24:27], v[76:79]
  v_mfma_f32_16x16x32_bf16 v[80:83], a[248:251], v[24:27], v[80:83]
  s_waitcnt vmcnt(6)
  ds_read_b64_tr_b16 v[118:119], v11 offset:2048
  v_mfma_f32_16x16x32_bf16 v[84:87], a[252:255], v[24:27], v[84:87]
  ds_read_b64_tr_b16 v[122:123], v12 offset:2048
  ds_read_b64_tr_b16 v[126:127], v13 offset:2048
  v_mfma_f32_16x16x32_bf16 v[88:91], v[112:115], v[24:27], v[88:91]
  ds_read_b128 v[24:27], v3 offset:21824
  ds_read_b64_tr_b16 v[130:131], v14 offset:2048
  s_waitcnt lgkmcnt(10)
  v_mfma_f32_16x16x32_bf16 v[92:95], a[240:243], v[16:19], v[92:95]
  s_waitcnt lgkmcnt(6)
  buffer_load_dwordx4 v6, s[20:23], s13 offen lds
  buffer_load_dwordx4 v6, s[20:23], s37 offen offset:1024 lds
  v_mfma_f32_16x16x32_bf16 v[96:99], a[244:247], v[16:19], v[96:99]
  s_add_u32 s37, s13, 3072
  v_mfma_f32_16x16x32_bf16 v[100:103], a[248:251], v[16:19], v[100:103]
  v_mfma_f32_16x16x32_bf16 v[104:107], a[252:255], v[16:19], v[104:107]
  s_waitcnt vmcnt(7)
  ds_read_b64_tr_b16 v[132:133], v15
  ds_read_b64_tr_b16 v[134:135], v15 offset:128
  v_mfma_f32_16x16x32_bf16 v[108:111], v[112:115], v[16:19], v[108:111]
  ds_read_b128 v[16:19], v3 offset:42816
  s_waitcnt lgkmcnt(7)
  v_mfma_f32_16x16x32_bf16 v[32:35], v[116:119], v[20:23], v[32:35]
  s_waitcnt lgkmcnt(6)
  v_mfma_f32_16x16x32_bf16 v[36:39], v[120:123], v[20:23], v[36:39]
  s_waitcnt lgkmcnt(5)
  v_mfma_f32_16x16x32_bf16 v[40:43], v[124:127], v[20:23], v[40:43]
  s_waitcnt lgkmcnt(3)
  buffer_load_dwordx4 v6, s[20:23], s37 offen offset:2048 lds
  s_add_u32 s37, s13, 22528
  v_mfma_f32_16x16x32_bf16 v[44:47], v[128:131], v[20:23], v[44:47]
  buffer_load_dwordx4 v6, s[20:23], s37 offen offset:3072 lds
  s_add_u32 m0, s42, 4096
  s_waitcnt lgkmcnt(1)
  v_mfma_f32_16x16x32_bf16 v[48:51], v[132:135], v[20:23], v[48:51]
  ds_read_b128 v[20:23], v3 offset:63808
  buffer_load_dwordx4 v7, s[20:23], s13 offen lds
  v_mfma_f32_16x16x32_bf16 v[52:55], v[116:119], v[24:27], v[52:55]
  s_add_u32 m0, s42, 20992
  s_waitcnt vmcnt(8)
  ds_read_b64_tr_b16 v[136:137], v11 offset:20992
  v_mfma_f32_16x16x32_bf16 v[56:59], v[120:123], v[24:27], v[56:59]
  s_add_u32 s13, s41, s9
  ds_read_b64_tr_b16 v[140:141], v12 offset:20992
  ds_read_b64_tr_b16 v[144:145], v13 offset:20992
  v_mfma_f32_16x16x32_bf16 v[60:63], v[124:127], v[24:27], v[60:63]
  s_add_u32 s37, s13, 19456
  ds_read_b64_tr_b16 v[148:149], v14 offset:20992
  v_mfma_f32_16x16x32_bf16 v[64:67], v[128:131], v[24:27], v[64:67]
  v_mfma_f32_16x16x32_bf16 v[68:71], v[132:135], v[24:27], v[68:71]
  ds_read_b128 v[24:27], v3 offset:896
  s_waitcnt lgkmcnt(6)
  v_mfma_f32_16x16x32_bf16 v[72:75], v[116:119], v[16:19], v[72:75]
  v_mfma_f32_16x16x32_bf16 v[76:79], v[120:123], v[16:19], v[76:79]
  v_mfma_f32_16x16x32_bf16 v[80:83], v[124:127], v[16:19], v[80:83]
  v_mfma_f32_16x16x32_bf16 v[84:87], v[128:131], v[16:19], v[84:87]
  s_waitcnt vmcnt(6)
  ds_read_b64_tr_b16 v[138:139], v11 offset:23040
  v_mfma_f32_16x16x32_bf16 v[88:91], v[132:135], v[16:19], v[88:91]
  ds_read_b128 v[16:19], v3 offset:21888
  ds_read_b64_tr_b16 v[142:143], v12 offset:23040
  s_waitcnt lgkmcnt(8)
  v_mfma_f32_16x16x32_bf16 v[92:95], v[116:119], v[20:23], v[92:95]
  ds_read_b64_tr_b16 v[146:147], v13 offset:23040
  ds_read_b64_tr_b16 v[150:151], v14 offset:23040
  v_mfma_f32_16x16x32_bf16 v[96:99], v[120:123], v[20:23], v[96:99]
  s_waitcnt lgkmcnt(6)
  buffer_load_dwordx4 v6, s[20:23], s13 offen lds
  buffer_load_dwordx4 v6, s[20:23], s37 offen offset:1024 lds
  v_mfma_f32_16x16x32_bf16 v[100:103], v[124:127], v[20:23], v[100:103]
  s_add_u32 s37, s13, 3072
  v_mfma_f32_16x16x32_bf16 v[104:107], v[128:131], v[20:23], v[104:107]
  v_mfma_f32_16x16x32_bf16 v[108:111], v[132:135], v[20:23], v[108:111]
  ds_read_b128 v[20:23], v3 offset:42880
  s_waitcnt vmcnt(7)
  ds_read_b64_tr_b16 v[152:153], v15 offset:20992
  ds_read_b64_tr_b16 v[154:155], v15 offset:21120
  s_waitcnt lgkmcnt(7)
  v_mfma_f32_16x16x32_bf16 v[32:35], v[136:139], v[24:27], v[32:35]
  s_waitcnt lgkmcnt(5)
  v_mfma_f32_16x16x32_bf16 v[36:39], v[140:143], v[24:27], v[36:39]
  s_waitcnt lgkmcnt(4)
  v_mfma_f32_16x16x32_bf16 v[40:43], v[144:147], v[24:27], v[40:43]
  s_waitcnt lgkmcnt(3)
  buffer_load_dwordx4 v6, s[20:23], s37 offen offset:2048 lds
  s_add_u32 s37, s13, 22528
  v_mfma_f32_16x16x32_bf16 v[44:47], v[148:151], v[24:27], v[44:47]
  buffer_load_dwordx4 v6, s[20:23], s37 offen offset:3072 lds
  s_add_u32 m0, s42, 25088
  s_waitcnt lgkmcnt(0)
  v_mfma_f32_16x16x32_bf16 v[48:51], v[152:155], v[24:27], v[48:51]
  ds_read_b128 v[24:27], v3 offset:63872
  s_waitcnt vmcnt(7)
  ds_read_b64_tr_b16 v[156:157], v11
  v_mfma_f32_16x16x32_bf16 v[52:55], v[136:139], v[16:19], v[52:55]
  ds_read_b64_tr_b16 v[160:161], v12
  ds_read_b64_tr_b16 v[164:165], v13
  v_mfma_f32_16x16x32_bf16 v[56:59], v[140:143], v[16:19], v[56:59]
  ds_read_b64_tr_b16 v[168:169], v14
  buffer_load_dwordx4 v7, s[20:23], s13 offen lds
  v_mfma_f32_16x16x32_bf16 v[60:63], v[144:147], v[16:19], v[60:63]
  s_add_u32 m0, s42, 0
  s_add_u32 s13, s41, s10
  s_add_u32 s37, s13, 19456
  v_mfma_f32_16x16x32_bf16 v[64:67], v[148:151], v[16:19], v[64:67]
  v_mfma_f32_16x16x32_bf16 v[68:71], v[152:155], v[16:19], v[68:71]
  ds_read_b128 v[16:19], v3 offset:960
  v_mfma_f32_16x16x32_bf16 v[72:75], v[136:139], v[20:23], v[72:75]
  v_mfma_f32_16x16x32_bf16 v[76:79], v[140:143], v[20:23], v[76:79]
  v_mfma_f32_16x16x32_bf16 v[80:83], v[144:147], v[20:23], v[80:83]
  s_waitcnt vmcnt(6)
  ds_read_b64_tr_b16 v[158:159], v11 offset:2048
  v_mfma_f32_16x16x32_bf16 v[84:87], v[148:151], v[20:23], v[84:87]
  ds_read_b64_tr_b16 v[162:163], v12 offset:2048
  ds_read_b64_tr_b16 v[166:167], v13 offset:2048
  v_mfma_f32_16x16x32_bf16 v[88:91], v[152:155], v[20:23], v[88:91]
  ds_read_b128 v[20:23], v3 offset:21952
  ds_read_b64_tr_b16 v[170:171], v14 offset:2048
  s_waitcnt lgkmcnt(10)
  v_mfma_f32_16x16x32_bf16 v[92:95], v[136:139], v[24:27], v[92:95]
  s_waitcnt lgkmcnt(6)
  buffer_load_dwordx4 v6, s[20:23], s13 offen lds
  buffer_load_dwordx4 v6, s[20:23], s37 offen offset:1024 lds
  v_mfma_f32_16x16x32_bf16 v[96:99], v[140:143], v[24:27], v[96:99]
  s_add_u32 s37, s13, 3072
  v_mfma_f32_16x16x32_bf16 v[100:103], v[144:147], v[24:27], v[100:103]
  v_mfma_f32_16x16x32_bf16 v[104:107], v[148:151], v[24:27], v[104:107]
  s_waitcnt vmcnt(7)
  ds_read_b64_tr_b16 v[172:173], v15
  ds_read_b64_tr_b16 v[174:175], v15 offset:128
  v_mfma_f32_16x16x32_bf16 v[108:111], v[152:155], v[24:27], v[108:111]
  ds_read_b128 v[24:27], v3 offset:42944
  s_waitcnt lgkmcnt(7)
  v_mfma_f32_16x16x32_bf16 v[32:35], v[156:159], v[16:19], v[32:35]
  s_waitcnt lgkmcnt(6)
  v_mfma_f32_16x16x32_bf16 v[36:39], v[160:163], v[16:19], v[36:39]
  s_waitcnt lgkmcnt(5)
  v_mfma_f32_16x16x32_bf16 v[40:43], v[164:167], v[16:19], v[40:43]
  s_waitcnt lgkmcnt(3)
  buffer_load_dwordx4 v6, s[20:23], s37 offen offset:2048 lds
  s_add_u32 s37, s13, 22528
  v_mfma_f32_16x16x32_bf16 v[44:47], v[168:171], v[16:19], v[44:47]
  buffer_load_dwordx4 v6, s[20:23], s37 offen offset:3072 lds
  s_add_u32 m0, s42, 4096
  s_waitcnt lgkmcnt(1)
  v_mfma_f32_16x16x32_bf16 v[48:51], v[172:175], v[16:19], v[48:51]
  ds_read_b128 v[16:19], v3 offset:63936
  buffer_load_dwordx4 v7, s[20:23], s13 offen lds
  v_mfma_f32_16x16x32_bf16 v[52:55], v[156:159], v[20:23], v[52:55]
  s_add_u32 m0, s42, 20992
  s_waitcnt vmcnt(8)
  ds_read_b64_tr_b16 v[176:177], v11 offset:20992
  v_mfma_f32_16x16x32_bf16 v[56:59], v[160:163], v[20:23], v[56:59]
  s_add_u32 s13, s41, s11
  ds_read_b64_tr_b16 v[180:181], v12 offset:20992
  ds_read_b64_tr_b16 v[184:185], v13 offset:20992
  v_mfma_f32_16x16x32_bf16 v[60:63], v[164:167], v[20:23], v[60:63]
  s_add_u32 s37, s13, 19456
  ds_read_b64_tr_b16 v[188:189], v14 offset:20992
  v_mfma_f32_16x16x32_bf16 v[64:67], v[168:171], v[20:23], v[64:67]
  v_mfma_f32_16x16x32_bf16 v[68:71], v[172:175], v[20:23], v[68:71]
  ds_read_b128 v[20:23], v3 offset:1024
  s_waitcnt lgkmcnt(6)
  v_mfma_f32_16x16x32_bf16 v[72:75], v[156:159], v[24:27], v[72:75]
  v_mfma_f32_16x16x32_bf16 v[76:79], v[160:163], v[24:27], v[76:79]
  v_mfma_f32_16x16x32_bf16 v[80:83], v[164:167], v[24:27], v[80:83]
  v_mfma_f32_16x16x32_bf16 v[84:87], v[168:171], v[24:27], v[84:87]
  s_waitcnt vmcnt(6)
  ds_read_b64_tr_b16 v[178:179], v11 offset:23040
  v_mfma_f32_16x16x32_bf16 v[88:91], v[172:175], v[24:27], v[88:91]
  ds_read_b128 v[24:27], v3 offset:22016
  ds_read_b64_tr_b16 v[182:183], v12 offset:23040
  s_waitcnt lgkmcnt(8)
  v_mfma_f32_16x16x32_bf16 v[92:95], v[156:159], v[16:19], v[92:95]
  ds_read_b64_tr_b16 v[186:187], v13 offset:23040
  ds_read_b64_tr_b16 v[190:191], v14 offset:23040
  v_mfma_f32_16x16x32_bf16 v[96:99], v[160:163], v[16:19], v[96:99]
  s_waitcnt lgkmcnt(6)
  buffer_load_dwordx4 v6, s[20:23], s13 offen lds
  buffer_load_dwordx4 v6, s[20:23], s37 offen offset:1024 lds
  v_mfma_f32_16x16x32_bf16 v[100:103], v[164:167], v[16:19], v[100:103]
  s_add_u32 s37, s13, 3072
  v_mfma_f32_16x16x32_bf16 v[104:107], v[168:171], v[16:19], v[104:107]
  v_mfma_f32_16x16x32_bf16 v[108:111], v[172:175], v[16:19], v[108:111]
  ds_read_b128 v[16:19], v3 offset:43008
  s_waitcnt vmcnt(7)
  ds_read_b64_tr_b16 v[192:193], v15 offset:20992
  ds_read_b64_tr_b16 v[194:195], v15 offset:21120
  s_waitcnt lgkmcnt(7)
  v_mfma_f32_16x16x32_bf16 v[32:35], v[176:179], v[20:23], v[32:35]
  s_waitcnt lgkmcnt(5)
  v_mfma_f32_16x16x32_bf16 v[36:39], v[180:183], v[20:23], v[36:39]
  s_waitcnt lgkmcnt(4)
  v_mfma_f32_16x16x32_bf16 v[40:43], v[184:187], v[20:23], v[40:43]
  s_waitcnt lgkmcnt(3)
  buffer_load_dwordx4 v6, s[20:23], s37 offen offset:2048 lds
  s_add_u32 s37, s13, 22528
  v_mfma_f32_16x16x32_bf16 v[44:47], v[188:191], v[20:23], v[44:47]
  buffer_load_dwordx4 v6, s[20:23], s37 offen offset:3072 lds
  s_add_u32 m0, s42, 25088
  s_waitcnt lgkmcnt(0)
  v_mfma_f32_16x16x32_bf16 v[48:51], v[192:195], v[20:23], v[48:51]
  ds_read_b128 v[20:23], v3 offset:64000
  s_waitcnt vmcnt(7)
  ds_read_b64_tr_b16 v[196:197], v11
  v_mfma_f32_16x16x32_bf16 v[52:55], v[176:179], v[24:27], v[52:55]
  ds_read_b64_tr_b16 v[200:201], v12
  ds_read_b64_tr_b16 v[204:205], v13
  v_mfma_f32_16x16x32_bf16 v[56:59], v[180:183], v[24:27], v[56:59]
  ds_read_b64_tr_b16 v[208:209], v14
  buffer_load_dwordx4 v7, s[20:23], s13 offen lds
  v_mfma_f32_16x16x32_bf16 v[60:63], v[184:187], v[24:27], v[60:63]
  s_add_u32 m0, s42, 0
  s_add_u32 s13, s41, s12
  s_add_u32 s37, s13, 19456
  v_mfma_f32_16x16x32_bf16 v[64:67], v[188:191], v[24:27], v[64:67]
  v_mfma_f32_16x16x32_bf16 v[68:71], v[192:195], v[24:27], v[68:71]
  ds_read_b128 v[24:27], v3 offset:1088
  v_mfma_f32_16x16x32_bf16 v[72:75], v[176:179], v[16:19], v[72:75]
  v_mfma_f32_16x16x32_bf16 v[76:79], v[180:183], v[16:19], v[76:79]
  v_mfma_f32_16x16x32_bf16 v[80:83], v[184:187], v[16:19], v[80:83]
  s_waitcnt vmcnt(6)
  ds_read_b64_tr_b16 v[198:199], v11 offset:2048
  v_mfma_f32_16x16x32_bf16 v[84:87], v[188:191], v[16:19], v[84:87]
  ds_read_b64_tr_b16 v[202:203], v12 offset:2048
  ds_read_b64_tr_b16 v[206:207], v13 offset:2048
  v_mfma_f32_16x16x32_bf16 v[88:91], v[192:195], v[16:19], v[88:91]
  ds_read_b128 v[16:19], v3 offset:22080
  ds_read_b64_tr_b16 v[210:211], v14 offset:2048
  s_waitcnt lgkmcnt(10)
  v_mfma_f32_16x16x32_bf16 v[92:95], v[176:179], v[20:23], v[92:95]
  s_waitcnt lgkmcnt(6)
  buffer_load_dwordx4 v6, s[20:23], s13 offen lds
  buffer_load_dwordx4 v6, s[20:23], s37 offen offset:1024 lds
  v_mfma_f32_16x16x32_bf16 v[96:99], v[180:183], v[20:23], v[96:99]
  s_add_u32 s37, s13, 3072
  v_mfma_f32_16x16x32_bf16 v[100:103], v[184:187], v[20:23], v[100:103]
  v_mfma_f32_16x16x32_bf16 v[104:107], v[188:191], v[20:23], v[104:107]
  s_waitcnt vmcnt(7)
  ds_read_b64_tr_b16 v[212:213], v15
  ds_read_b64_tr_b16 v[214:215], v15 offset:128
  v_mfma_f32_16x16x32_bf16 v[108:111], v[192:195], v[20:23], v[108:111]
  ds_read_b128 v[20:23], v3 offset:43072
  s_waitcnt lgkmcnt(7)
  v_mfma_f32_16x16x32_bf16 v[32:35], v[196:199], v[24:27], v[32:35]
  s_waitcnt lgkmcnt(6)
  v_mfma_f32_16x16x32_bf16 v[36:39], v[200:203], v[24:27], v[36:39]
  s_waitcnt lgkmcnt(5)
  v_mfma_f32_16x16x32_bf16 v[40:43], v[204:207], v[24:27], v[40:43]
  s_waitcnt lgkmcnt(3)
  buffer_load_dwordx4 v6, s[20:23], s37 offen offset:2048 lds
  s_add_u32 s37, s13, 22528
  v_mfma_f32_16x16x32_bf16 v[44:47], v[208:211], v[24:27], v[44:47]
  buffer_load_dwordx4 v6, s[20:23], s37 offen offset:3072 lds
  s_add_u32 m0, s42, 4096
  v_mov_b32 v6, v29
  s_waitcnt lgkmcnt(1)
  v_mfma_f32_16x16x32_bf16 v[48:51], v[212:215], v[24:27], v[48:51]
  ds_read_b128 v[24:27], v3 offset:64064
  buffer_load_dwordx4 v7, s[20:23], s13 offen lds
  v_mfma_f32_16x16x32_bf16 v[52:55], v[196:199], v[16:19], v[52:55]
  s_barrier
  v_mfma_f32_16x16x32_bf16 v[56:59], v[200:203], v[16:19], v[56:59]
  s_add_u32 m0, s40, 0
  s_waitcnt vmcnt(8)
  ds_read_b64_tr_b16 v[216:217], v11 offset:20992
  v_mfma_f32_16x16x32_bf16 v[60:63], v[204:207], v[16:19], v[60:63]
  ds_read_b64_tr_b16 v[220:221], v12 offset:20992
  ds_read_b64_tr_b16 v[224:225], v13 offset:20992
  v_mfma_f32_16x16x32_bf16 v[64:67], v[208:211], v[16:19], v[64:67]
  ds_read_b64_tr_b16 v[228:229], v14 offset:20992
  v_xor_b32 v7, 64, v29
  v_mfma_f32_16x16x32_bf16 v[68:71], v[212:215], v[16:19], v[68:71]
  ds_read_b128 v[16:19], v3 offset:1152
  buffer_load_dwordx4 v1, s[16:19], s28 offen nt lds
  s_waitcnt lgkmcnt(6)
  v_mfma_f32_16x16x32_bf16 v[72:75], v[196:199], v[20:23], v[72:75]
  s_add_u32 m0, s40, 1312
  v_mov_b32 v29, 0
  buffer_load_dwordx4 v1, s[16:19], s29 offen nt lds
  v_mfma_f32_16x16x32_bf16 v[76:79], v[200:203], v[20:23], v[76:79]
  s_add_u32 m0, s40, 2624
  v_mfma_f32_16x16x32_bf16 v[80:83], v[204:207], v[20:23], v[80:83]
  v_mfma_f32_16x16x32_bf16 v[84:87], v[208:211], v[20:23], v[84:87]
  s_waitcnt vmcnt(8)
  ds_read_b64_tr_b16 v[218:219], v11 offset:23040
  ds_read_b64_tr_b16 v[222:223], v12 offset:23040
  v_mfma_f32_16x16x32_bf16 v[88:91], v[212:215], v[20:23], v[88:91]
  ds_read_b128 v[20:23], v3 offset:22144
  ds_read_b64_tr_b16 v[226:227], v13 offset:23040
  s_waitcnt lgkmcnt(9)
  v_mfma_f32_16x16x32_bf16 v[92:95], v[196:199], v[24:27], v[92:95]
  ds_read_b64_tr_b16 v[230:231], v14 offset:23040
  buffer_load_dwordx4 v1, s[16:19], s30 offen nt lds
  v_mfma_f32_16x16x32_bf16 v[96:99], v[200:203], v[24:27], v[96:99]
  s_add_u32 m0, s40, 3936
  v_mfma_f32_16x16x32_bf16 v[100:103], v[204:207], v[24:27], v[100:103]
  v_mfma_f32_16x16x32_bf16 v[104:107], v[208:211], v[24:27], v[104:107]
  s_waitcnt vmcnt(8)
  ds_read_b64_tr_b16 v[232:233], v15 offset:20992
  ds_read_b64_tr_b16 v[234:235], v15 offset:21120
  v_mfma_f32_16x16x32_bf16 v[108:111], v[212:215], v[24:27], v[108:111]
  ds_read_b128 v[24:27], v3 offset:43136
  buffer_load_dwordx4 v1, s[16:19], s31 offen nt lds
  s_add_u32 m0, s40, 5248
  s_waitcnt lgkmcnt(7)
  v_mfma_f32_16x16x32_bf16 v[32:35], v[216:219], v[16:19], v[32:35]
  s_waitcnt lgkmcnt(6)
  v_mfma_f32_16x16x32_bf16 v[36:39], v[220:223], v[16:19], v[36:39]
  s_waitcnt lgkmcnt(4)
  v_mfma_f32_16x16x32_bf16 v[40:43], v[224:227], v[16:19], v[40:43]
  buffer_load_dwordx4 v1, s[16:19], s32 offen nt lds
  v_add_u32 v1, 20480, v1
  s_waitcnt lgkmcnt(3)
  v_mfma_f32_16x16x32_bf16 v[44:47], v[228:231], v[16:19], v[44:47]
  s_add_u32 m0, s40, 26240
  s_waitcnt lgkmcnt(1)
  v_mfma_f32_16x16x32_bf16 v[48:51], v[232:235], v[16:19], v[48:51]
  ds_write_b128 v2, v[236:239] offset:62976
  v_mfma_f32_16x16x32_bf16 v[52:55], v[216:219], v[20:23], v[52:55]
  ds_read_b128 v[16:19], v3 offset:64128
  s_waitcnt vmcnt(8)
  ds_read_b64_tr_b16 v[236:237], v11
  v_mfma_f32_16x16x32_bf16 v[56:59], v[220:223], v[20:23], v[56:59]
  v_mfma_f32_16x16x32_bf16 v[60:63], v[224:227], v[20:23], v[60:63]
  ds_write_b128 v2, v[240:243] offset:63232
  v_mfma_f32_16x16x32_bf16 v[64:67], v[228:231], v[20:23], v[64:67]
  s_nop 0
  ds_read_b64_tr_b16 v[240:241], v12
  v_mfma_f32_16x16x32_bf16 v[68:71], v[232:235], v[20:23], v[68:71]
  ds_read_b128 v[20:23], v3 offset:1216
  s_waitcnt lgkmcnt(6)
  v_mfma_f32_16x16x32_bf16 v[72:75], v[216:219], v[24:27], v[72:75]
  ds_write_b128 v2, v[244:247] offset:63488
  v_mfma_f32_16x16x32_bf16 v[76:79], v[220:223], v[24:27], v[76:79]
  s_nop 0
  ds_read_b64_tr_b16 v[244:245], v13
  s_waitcnt vmcnt(6)
  ds_read_b64_tr_b16 v[238:239], v11 offset:2048
  v_mfma_f32_16x16x32_bf16 v[80:83], v[224:227], v[24:27], v[80:83]
  ds_read_b64_tr_b16 v[242:243], v12 offset:2048
  ds_read_b64_tr_b16 v[246:247], v13 offset:2048
  v_mfma_f32_16x16x32_bf16 v[84:87], v[228:231], v[24:27], v[84:87]
  ds_write_b128 v2, v[248:251] offset:63744
  v_mfma_f32_16x16x32_bf16 v[88:91], v[232:235], v[24:27], v[88:91]
  ds_read_b128 v[24:27], v3 offset:22208
  ds_read_b64_tr_b16 v[248:249], v14
  s_waitcnt lgkmcnt(12)
  v_mfma_f32_16x16x32_bf16 v[92:95], v[216:219], v[16:19], v[92:95]
  ds_read_b64_tr_b16 v[250:251], v14 offset:2048
  v_mov_b32 v11, v28
  v_mfma_f32_16x16x32_bf16 v[96:99], v[220:223], v[16:19], v[96:99]
  ds_write_b128 v2, v[252:255] offset:64000
  v_mfma_f32_16x16x32_bf16 v[100:103], v[224:227], v[16:19], v[100:103]
  s_waitcnt vmcnt(5)
  ds_read_b64_tr_b16 v[252:253], v15
  ds_read_b64_tr_b16 v[254:255], v15 offset:128
  v_mfma_f32_16x16x32_bf16 v[104:107], v[228:231], v[16:19], v[104:107]
  v_mfma_f32_16x16x32_bf16 v[108:111], v[232:235], v[16:19], v[108:111]
  ds_read_b128 v[16:19], v3 offset:43200
  buffer_load_dwordx4 v1, s[16:19], s28 offen nt lds
  s_waitcnt lgkmcnt(10)
  v_mfma_f32_16x16x32_bf16 v[32:35], v[236:239], v[20:23], v[32:35]
  s_add_u32 m0, s40, 27552
  s_nop 0
  buffer_load_dwordx4 v1, s[16:19], s29 offen nt lds
  s_waitcnt lgkmcnt(9)
  v_mfma_f32_16x16x32_bf16 v[36:39], v[240:243], v[20:23], v[36:39]
  s_add_u32 m0, s40, 28864
  s_nop 0
  buffer_load_dwordx4 v1, s[16:19], s30 offen nt lds
  s_waitcnt lgkmcnt(8)
  v_mfma_f32_16x16x32_bf16 v[40:43], v[244:247], v[20:23], v[40:43]
  s_add_u32 m0, s40, 30176
  s_waitcnt lgkmcnt(4)
  v_mfma_f32_16x16x32_bf16 v[44:47], v[248:251], v[20:23], v[44:47]
  buffer_load_dwordx4 v1, s[16:19], s31 offen nt lds
  s_add_u32 m0, s40, 31488
  s_waitcnt lgkmcnt(1)
  v_mfma_f32_16x16x32_bf16 v[48:51], v[252:255], v[20:23], v[48:51]
  ds_read_b128 v[20:23], v3 offset:64192
  v_add_u32 v3, 62976, v3
  v_mfma_f32_16x16x32_bf16 v[52:55], v[236:239], v[24:27], v[52:55]
  v_mfma_f32_16x16x32_bf16 v[56:59], v[240:243], v[24:27], v[56:59]
  buffer_load_dwordx4 v1, s[16:19], s32 offen nt lds
  v_mfma_f32_16x16x32_bf16 v[60:63], v[244:247], v[24:27], v[60:63]
  s_nop 4
  v_cvt_pk_bf16_f32 v52, v52, v53
  v_mfma_f32_16x16x32_bf16 v[64:67], v[248:251], v[24:27], v[64:67]
  v_cvt_pk_bf16_f32 v53, v54, v55
  v_cvt_pk_bf16_f32 v54, v56, v57
  v_mfma_f32_16x16x32_bf16 v[68:71], v[252:255], v[24:27], v[68:71]
  ds_read_b128 v[24:27], v3 offset:20992
  v_cvt_pk_bf16_f32 v55, v58, v59
  s_waitcnt lgkmcnt(2)
  v_mfma_f32_16x16x32_bf16 v[72:75], v[236:239], v[16:19], v[72:75]
  v_cvt_pk_bf16_f32 v60, v60, v61
  v_cvt_pk_bf16_f32 v61, v62, v63
  v_mfma_f32_16x16x32_bf16 v[76:79], v[240:243], v[16:19], v[76:79]
  v_cvt_pk_bf16_f32 v62, v64, v65
  v_cvt_pk_bf16_f32 v63, v66, v67
  v_mfma_f32_16x16x32_bf16 v[80:83], v[244:247], v[16:19], v[80:83]
  v_cvt_pk_bf16_f32 v68, v68, v69
  v_cvt_pk_bf16_f32 v69, v70, v71
  v_mfma_f32_16x16x32_bf16 v[84:87], v[248:251], v[16:19], v[84:87]
  v_cvt_pk_bf16_f32 v56, v32, v33
  v_cvt_pk_bf16_f32 v57, v34, v35
  v_mfma_f32_16x16x32_bf16 v[88:91], v[252:255], v[16:19], v[88:91]
  ds_read_b128 v[16:19], v3 offset:21056
  v_cvt_pk_bf16_f32 v58, v36, v37
  s_waitcnt lgkmcnt(2)
  v_mfma_f32_16x16x32_bf16 v[92:95], v[236:239], v[20:23], v[92:95]
  v_cvt_pk_bf16_f32 v59, v38, v39
  v_cvt_pk_bf16_f32 v64, v40, v41
  v_mfma_f32_16x16x32_bf16 v[96:99], v[240:243], v[20:23], v[96:99]
  v_cvt_pk_bf16_f32 v65, v42, v43
  v_cvt_pk_bf16_f32 v66, v44, v45
  v_mfma_f32_16x16x32_bf16 v[100:103], v[244:247], v[20:23], v[100:103]
  v_cvt_pk_bf16_f32 v67, v46, v47
  v_cvt_pk_bf16_f32 v70, v48, v49
  v_mfma_f32_16x16x32_bf16 v[104:107], v[248:251], v[20:23], v[104:107]
  v_cvt_pk_bf16_f32 v71, v50, v51
  ds_write_b64 v9, v[70:71]
  v_mfma_f32_16x16x32_bf16 v[108:111], v[252:255], v[20:23], v[108:111]
  ds_read_b128 v[20:23], v3 offset:21120
  v_permlane16_swap_b32 v56, v58
  s_waitcnt lgkmcnt(3)
  v_mfma_f32_16x16x32_bf16 v[32:35], a[0:3], v[24:27], 0
  v_permlane16_swap_b32 v57, v59
  v_permlane16_swap_b32 v64, v66
  v_mfma_f32_16x16x32_bf16 v[36:39], a[4:7], v[24:27], 0
  v_permlane16_swap_b32 v65, v67
  ds_write_b64 v9, v[68:69] offset:2176
  v_mfma_f32_16x16x32_bf16 v[40:43], a[8:11], v[24:27], 0
  v_permlane16_swap_b32 v52, v54
  v_permlane16_swap_b32 v53, v55
  v_mfma_f32_16x16x32_bf16 v[44:47], a[12:15], v[24:27], 0
  v_permlane16_swap_b32 v60, v62
  v_permlane16_swap_b32 v61, v63
  v_mfma_f32_16x16x32_bf16 v[48:51], a[16:19], v[24:27], 0
  ds_read_b128 v[24:27], v3 offset:21184
  v_cvt_pk_bf16_f32 v92, v92, v93
  s_waitcnt lgkmcnt(4)
  v_mfma_f32_16x16x32_bf16 v[32:35], a[20:23], v[16:19], v[32:35]
  ds_write_b128 v6, v[56:59]
  v_mfma_f32_16x16x32_bf16 v[36:39], a[24:27], v[16:19], v[36:39]
  v_cvt_pk_bf16_f32 v93, v94, v95
  v_cvt_pk_bf16_f32 v94, v96, v97
  v_mfma_f32_16x16x32_bf16 v[40:43], a[28:31], v[16:19], v[40:43]
  v_cvt_pk_bf16_f32 v95, v98, v99
  v_cvt_pk_bf16_f32 v100, v100, v101
  v_mfma_f32_16x16x32_bf16 v[44:47], a[32:35], v[16:19], v[44:47]
  ds_write_b128 v7, v[64:67]
  v_mfma_f32_16x16x32_bf16 v[48:51], a[36:39], v[16:19], v[48:51]
  ds_read_b128 v[16:19], v3 offset:21248
  v_cvt_pk_bf16_f32 v101, v102, v103
  s_waitcnt lgkmcnt(5)
  v_mfma_f32_16x16x32_bf16 v[32:35], a[40:43], v[20:23], v[32:35]
  v_cvt_pk_bf16_f32 v102, v104, v105
  v_cvt_pk_bf16_f32 v103, v106, v107
  v_mfma_f32_16x16x32_bf16 v[36:39], a[44:47], v[20:23], v[36:39]
  ds_write_b128 v6, v[52:55] offset:2048
  v_mfma_f32_16x16x32_bf16 v[40:43], a[48:51], v[20:23], v[40:43]
  v_cvt_pk_bf16_f32 v108, v108, v109
  v_cvt_pk_bf16_f32 v109, v110, v111
  v_mfma_f32_16x16x32_bf16 v[44:47], a[52:55], v[20:23], v[44:47]
  v_cvt_pk_bf16_f32 v96, v72, v73
  v_cvt_pk_bf16_f32 v97, v74, v75
  v_mfma_f32_16x16x32_bf16 v[48:51], a[56:59], v[20:23], v[48:51]
  ds_read_b128 v[20:23], v3 offset:21312
  ds_write_b128 v7, v[60:63] offset:2048
  s_waitcnt lgkmcnt(6)
  v_mfma_f32_16x16x32_bf16 v[32:35], a[60:63], v[24:27], v[32:35]
  v_cvt_pk_bf16_f32 v98, v76, v77
  v_cvt_pk_bf16_f32 v99, v78, v79
  v_mfma_f32_16x16x32_bf16 v[36:39], a[64:67], v[24:27], v[36:39]
  v_cvt_pk_bf16_f32 v104, v80, v81
  v_cvt_pk_bf16_f32 v105, v82, v83
  v_mfma_f32_16x16x32_bf16 v[40:43], a[68:71], v[24:27], v[40:43]
  v_cvt_pk_bf16_f32 v106, v84, v85
  v_cvt_pk_bf16_f32 v107, v86, v87
  v_mfma_f32_16x16x32_bf16 v[44:47], a[72:75], v[24:27], v[44:47]
  v_cvt_pk_bf16_f32 v110, v88, v89
  v_cvt_pk_bf16_f32 v111, v90, v91
  v_mfma_f32_16x16x32_bf16 v[48:51], a[76:79], v[24:27], v[48:51]
  ds_read_b128 v[24:27], v3 offset:21376
  ds_write_b64 v9, v[110:111] offset:4352
  s_waitcnt lgkmcnt(5)
  v_mfma_f32_16x16x32_bf16 v[32:35], a[80:83], v[16:19], v[32:35]
  v_permlane16_swap_b32 v96, v98
  v_permlane16_swap_b32 v97, v99
  v_mfma_f32_16x16x32_bf16 v[36:39], a[84:87], v[16:19], v[36:39]
  v_permlane16_swap_b32 v104, v106
  v_permlane16_swap_b32 v105, v107
  v_mfma_f32_16x16x32_bf16 v[40:43], a[88:91], v[16:19], v[40:43]
  v_permlane16_swap_b32 v92, v94
  v_permlane16_swap_b32 v93, v95
  v_mfma_f32_16x16x32_bf16 v[44:47], a[92:95], v[16:19], v[44:47]
  ds_write_b64 v9, v[108:109] offset:6528
  v_mfma_f32_16x16x32_bf16 v[48:51], a[96:99], v[16:19], v[48:51]
  ds_read_b128 v[16:19], v3 offset:21440
  v_permlane16_swap_b32 v100, v102
  s_waitcnt lgkmcnt(5)
  v_mfma_f32_16x16x32_bf16 v[32:35], a[100:103], v[20:23], v[32:35]
  v_permlane16_swap_b32 v101, v103
  s_waitcnt vmcnt(9)
  ds_read_b128 v[52:55], v5
  v_mfma_f32_16x16x32_bf16 v[36:39], a[104:107], v[20:23], v[36:39]
  s_waitcnt vmcnt(8)
  ds_read_b128 v[56:59], v5 offset:1312
  s_waitcnt vmcnt(7)
  ds_read_b128 v[60:63], v5 offset:2624
  v_mfma_f32_16x16x32_bf16 v[40:43], a[108:111], v[20:23], v[40:43]
  s_waitcnt vmcnt(6)
  ds_read_b128 v[64:67], v5 offset:3936
  s_waitcnt vmcnt(5)
  ds_read_b128 v[68:71], v5 offset:5248
  v_mfma_f32_16x16x32_bf16 v[44:47], a[112:115], v[20:23], v[44:47]
  ds_read_b128 v[76:79], v4 offset:0
  ds_read_b128 v[80:83], v4 offset:512
  v_mfma_f32_16x16x32_bf16 v[48:51], a[116:119], v[20:23], v[48:51]
  ds_read_b128 v[20:23], v3 offset:21504
  ds_read_b128 v[84:87], v4 offset:256
  s_waitcnt lgkmcnt(12)
  v_mfma_f32_16x16x32_bf16 v[32:35], a[120:123], v[24:27], v[32:35]
  ds_read_b128 v[88:91], v4 offset:768
  v_mfma_f32_16x16x32_bf16 v[36:39], a[124:127], v[24:27], v[36:39]
  v_mfma_f32_16x16x32_bf16 v[40:43], a[128:131], v[24:27], v[40:43]
  s_waitcnt lgkmcnt(9)
  v_lshlrev_b32 v72, 16, v52
  v_and_b32 v73, s46, v52
  v_mfma_f32_16x16x32_bf16 v[44:47], a[132:135], v[24:27], v[44:47]
  v_lshlrev_b32 v74, 16, v53
  v_and_b32 v75, s46, v53
  v_mfma_f32_16x16x32_bf16 v[48:51], a[136:139], v[24:27], v[48:51]
  ds_read_b128 v[24:27], v3 offset:21568
  v_mfma_f32_16x16x32_bf16 v[32:35], a[140:143], v[16:19], v[32:35]
  s_waitcnt lgkmcnt(6)
  v_dot2c_f32_bf16 v29, s47, v52
  v_dot2c_f32_bf16 v31, v52, v52
  v_dot2c_f32_bf16 v29, s47, v53
  v_dot2c_f32_bf16 v31, v53, v53
  v_dot2c_f32_bf16 v29, s47, v54
  v_dot2c_f32_bf16 v31, v54, v54
  v_dot2c_f32_bf16 v29, s47, v55
  v_dot2c_f32_bf16 v31, v55, v55
  v_dot2c_f32_bf16 v29, s47, v56
  v_dot2c_f32_bf16 v31, v56, v56
  v_dot2c_f32_bf16 v29, s47, v57
  v_dot2c_f32_bf16 v31, v57, v57
  v_dot2c_f32_bf16 v29, s47, v58
  v_dot2c_f32_bf16 v31, v58, v58
  v_dot2c_f32_bf16 v29, s47, v59
  v_dot2c_f32_bf16 v31, v59, v59
  v_dot2c_f32_bf16 v29, s47, v60
  v_dot2c_f32_bf16 v31, v60, v60
  v_dot2c_f32_bf16 v29, s47, v61
  v_dot2c_f32_bf16 v31, v61, v61
  v_dot2c_f32_bf16 v29, s47, v62
  v_dot2c_f32_bf16 v31, v62, v62
  v_dot2c_f32_bf16 v29, s47, v63
  v_dot2c_f32_bf16 v31, v63, v63
  v_dot2c_f32_bf16 v29, s47, v64
  v_dot2c_f32_bf16 v31, v64, v64
  v_dot2c_f32_bf16 v29, s47, v65
  v_dot2c_f32_bf16 v31, v65, v65
  v_dot2c_f32_bf16 v29, s47, v66
  v_dot2c_f32_bf16 v31, v66, v66
  v_dot2c_f32_bf16 v29, s47, v67
  v_dot2c_f32_bf16 v31, v67, v67
  v_dot2c_f32_bf16 v29, s47, v68
  v_dot2c_f32_bf16 v31, v68, v68
  v_dot2c_f32_bf16 v29, s47, v69
  v_dot2c_f32_bf16 v31, v69, v69
  v_dot2c_f32_bf16 v29, s47, v70
  v_dot2c_f32_bf16 v31, v70, v70
  v_dot2c_f32_bf16 v29, s47, v71
  v_dot2c_f32_bf16 v31, v71, v71
  v_mfma_f32_16x16x32_bf16 v[36:39], a[144:147], v[16:19], v[36:39]
  s_nop 0
  v_add_f32_dpp v29, v29, v29 row_ror:8 row_mask:0xf bank_mask:0xf
  v_add_f32_dpp v31, v31, v31 row_ror:8 row_mask:0xf bank_mask:0xf
  v_mfma_f32_16x16x32_bf16 v[40:43], a[148:151], v[16:19], v[40:43]
  v_add_f32_dpp v29, v29, v29 row_ror:4 row_mask:0xf bank_mask:0xf
  v_add_f32_dpp v31, v31, v31 row_ror:4 row_mask:0xf bank_mask:0xf
  v_mfma_f32_16x16x32_bf16 v[44:47], a[152:155], v[16:19], v[44:47]
  v_add_f32_dpp v29, v29, v29 row_ror:2 row_mask:0xf bank_mask:0xf
  v_add_f32_dpp v31, v31, v31 row_ror:2 row_mask:0xf bank_mask:0xf
  v_mfma_f32_16x16x32_bf16 v[48:51], a[156:159], v[16:19], v[48:51]
  ds_read_b128 v[16:19], v3 offset:21632
  v_add_f32_dpp v29, v29, v29 row_ror:1 row_mask:0xf bank_mask:0xf
  s_waitcnt lgkmcnt(4)
  v_mfma_f32_16x16x32_bf16 v[32:35], a[160:163], v[20:23], v[32:35]
  v_add_f32_dpp v31, v31, v31 row_ror:1 row_mask:0xf bank_mask:0xf
  v_mul_f32 v28, v29, v29
  v_mfma_f32_16x16x32_bf16 v[36:39], a[164:167], v[20:23], v[36:39]
  v_fma_f32 v30, v29, v29, -v28
  v_fma_f32 v31, v31, s52, -v28
  v_mfma_f32_16x16x32_bf16 v[40:43], a[168:171], v[20:23], v[40:43]
  v_sub_f32 v31, v31, v30
  v_max_f32 v31, 0, v31
  v_mfma_f32_16x16x32_bf16 v[44:47], a[172:175], v[20:23], v[44:47]
  v_add_f32 v31, s53, v31
  v_rsq_f32 v31, v31
  v_mfma_f32_16x16x32_bf16 v[48:51], a[176:179], v[20:23], v[48:51]
  s_barrier
  s_waitcnt lgkmcnt(1)
  v_mfma_f32_16x16x32_bf16 v[32:35], a[180:183], v[24:27], v[32:35]
  ds_read_b128 v[20:23], v3 offset:21696
  v_mul_f32 v28, s52, v31
  v_mfma_f32_16x16x32_bf16 v[36:39], a[184:187], v[24:27], v[36:39]
  v_fma_f32 v30, -v29, v31, 0
  v_fma_f32 v72, v72, v28, v30
  v_mfma_f32_16x16x32_bf16 v[40:43], a[188:191], v[24:27], v[40:43]
  v_fma_f32 v73, v73, v28, v30
  v_fma_f32 v74, v74, v28, v30
  v_mfma_f32_16x16x32_bf16 v[44:47], a[192:195], v[24:27], v[44:47]
  v_fma_f32 v75, v75, v28, v30
  v_fmac_f32 v80, v72, v76
  v_mfma_f32_16x16x32_bf16 v[48:51], a[196:199], v[24:27], v[48:51]
  ds_read_b128 v[24:27], v3 offset:21760
  v_fmac_f32 v81, v73, v77
  s_waitcnt lgkmcnt(2)
  v_mfma_f32_16x16x32_bf16 v[32:35], a[200:203], v[16:19], v[32:35]
  v_fmac_f32 v82, v74, v78
  v_fmac_f32 v83, v75, v79
  v_mfma_f32_16x16x32_bf16 v[36:39], a[204:207], v[16:19], v[36:39]
  ds_read_b128 v[76:79], v4 offset:1024
  v_cvt_pk_bf16_f32 v52, v80, v81
  v_mfma_f32_16x16x32_bf16 v[40:43], a[208:211], v[16:19], v[40:43]
  v_cvt_pk_bf16_f32 v53, v82, v83
  ds_read_b128 v[80:83], v4 offset:1536
  v_mfma_f32_16x16x32_bf16 v[44:47], a[212:215], v[16:19], v[44:47]
  v_lshlrev_b32 v72, 16, v54
  v_and_b32 v73, s46, v54
  v_mfma_f32_16x16x32_bf16 v[48:51], a[216:219], v[16:19], v[48:51]
  ds_read_b128 v[16:19], v3 offset:21824
  v_lshlrev_b32 v74, 16, v55
  s_waitcnt lgkmcnt(4)
  v_mfma_f32_16x16x32_bf16 v[32:35], a[220:223], v[20:23], v[32:35]
  v_and_b32 v75, s46, v55
  v_fma_f32 v72, v72, v28, v30
  v_mfma_f32_16x16x32_bf16 v[36:39], a[224:227], v[20:23], v[36:39]
  v_fma_f32 v73, v73, v28, v30
  v_fma_f32 v74, v74, v28, v30
  v_mfma_f32_16x16x32_bf16 v[40:43], a[228:231], v[20:23], v[40:43]
  v_fma_f32 v75, v75, v28, v30
  v_fmac_f32 v88, v72, v84
  v_mfma_f32_16x16x32_bf16 v[44:47], a[232:235], v[20:23], v[44:47]
  v_fmac_f32 v89, v73, v85
  v_fmac_f32 v90, v74, v86
  v_mfma_f32_16x16x32_bf16 v[48:51], a[236:239], v[20:23], v[48:51]
  ds_read_b128 v[20:23], v3 offset:21888
  ds_read_b128 v[12:15], v11
  s_waitcnt lgkmcnt(5)
  v_mfma_f32_16x16x32_bf16 v[32:35], a[240:243], v[24:27], v[32:35]
  v_fmac_f32 v91, v75, v87
  ds_read_b128 v[84:87], v4 offset:1280
  v_mfma_f32_16x16x32_bf16 v[36:39], a[244:247], v[24:27], v[36:39]
  v_cvt_pk_bf16_f32 v54, v88, v89
  v_cvt_pk_bf16_f32 v55, v90, v91
  v_mfma_f32_16x16x32_bf16 v[40:43], a[248:251], v[24:27], v[40:43]
  ds_write_b128 v2, v[52:55]
  v_mfma_f32_16x16x32_bf16 v[44:47], a[252:255], v[24:27], v[44:47]
  ds_read_b128 v[88:91], v4 offset:1792
  v_lshlrev_b32 v72, 16, v56
  v_mfma_f32_16x16x32_bf16 v[48:51], v[112:115], v[24:27], v[48:51]
  ds_read_b128 v[24:27], v3 offset:21952
  v_and_b32 v73, s46, v56
  s_waitcnt lgkmcnt(6)
  v_mfma_f32_16x16x32_bf16 v[32:35], v[116:119], v[16:19], v[32:35]
  v_lshlrev_b32 v74, 16, v57
  v_and_b32 v75, s46, v57
  v_mfma_f32_16x16x32_bf16 v[36:39], v[120:123], v[16:19], v[36:39]
  s_waitcnt lgkmcnt(4)
  buffer_store_dwordx4 v[12:15], v8, s[24:27], s43 offen sc1
  v_mfma_f32_16x16x32_bf16 v[40:43], v[124:127], v[16:19], v[40:43]
  s_add_u32 s43, s43, 20480
  v_fma_f32 v72, v72, v28, v30
  v_fma_f32 v73, v73, v28, v30
  v_mfma_f32_16x16x32_bf16 v[44:47], v[128:131], v[16:19], v[44:47]
  v_fma_f32 v74, v74, v28, v30
  v_fma_f32 v75, v75, v28, v30
  v_mfma_f32_16x16x32_bf16 v[48:51], v[132:135], v[16:19], v[48:51]
  ds_read_b128 v[16:19], v3 offset:22016
  ds_read_b128 v[12:15], v11 offset:1024
  v_mfma_f32_16x16x32_bf16 v[32:35], v[136:139], v[20:23], v[32:35]
  ds_write_b128 v6, v[96:99]
  v_mfma_f32_16x16x32_bf16 v[36:39], v[140:143], v[20:23], v[36:39]
  v_fmac_f32 v80, v72, v76
  v_fmac_f32 v81, v73, v77
  v_mfma_f32_16x16x32_bf16 v[40:43], v[144:147], v[20:23], v[40:43]
  v_fmac_f32 v82, v74, v78
  v_fmac_f32 v83, v75, v79
  v_mfma_f32_16x16x32_bf16 v[44:47], v[148:151], v[20:23], v[44:47]
  ds_write_b128 v7, v[104:107]
  v_mfma_f32_16x16x32_bf16 v[48:51], v[152:155], v[20:23], v[48:51]
  ds_read_b128 v[20:23], v3 offset:22080
  ds_read_b128 v[76:79], v4 offset:2048
  s_waitcnt lgkmcnt(6)
  v_mfma_f32_16x16x32_bf16 v[32:35], v[156:159], v[24:27], v[32:35]
  v_cvt_pk_bf16_f32 v56, v80, v81
  v_cvt_pk_bf16_f32 v57, v82, v83
  v_mfma_f32_16x16x32_bf16 v[36:39], v[160:163], v[24:27], v[36:39]
  s_waitcnt lgkmcnt(4)
  buffer_store_dwordx4 v[12:15], v8, s[24:27], s39 offen sc1
  v_mfma_f32_16x16x32_bf16 v[40:43], v[164:167], v[24:27], v[40:43]
  s_add_u32 s39, s39, 20480
  ds_read_b128 v[80:83], v4 offset:2560
  v_lshlrev_b32 v72, 16, v58
  v_mfma_f32_16x16x32_bf16 v[44:47], v[168:171], v[24:27], v[44:47]
  v_and_b32 v73, s46, v58
  v_lshlrev_b32 v74, 16, v59
  v_mfma_f32_16x16x32_bf16 v[48:51], v[172:175], v[24:27], v[48:51]
  ds_read_b128 v[24:27], v3 offset:22144
  ds_read_b128 v[12:15], v11 offset:2048
  v_mfma_f32_16x16x32_bf16 v[32:35], v[176:179], v[16:19], v[32:35]
  v_and_b32 v75, s46, v59
  v_fma_f32 v72, v72, v28, v30
  v_mfma_f32_16x16x32_bf16 v[36:39], v[180:183], v[16:19], v[36:39]
  v_fma_f32 v73, v73, v28, v30
  v_fma_f32 v74, v74, v28, v30
  v_mfma_f32_16x16x32_bf16 v[40:43], v[184:187], v[16:19], v[40:43]
  v_fma_f32 v75, v75, v28, v30
  v_fmac_f32 v88, v72, v84
  v_mfma_f32_16x16x32_bf16 v[44:47], v[188:191], v[16:19], v[44:47]
  v_fmac_f32 v89, v73, v85
  v_fmac_f32 v90, v74, v86
  v_mfma_f32_16x16x32_bf16 v[48:51], v[192:195], v[16:19], v[48:51]
  ds_read_b128 v[16:19], v3 offset:22208
  v_fmac_f32 v91, v75, v87
  s_waitcnt lgkmcnt(5)
  v_mfma_f32_16x16x32_bf16 v[32:35], v[196:199], v[20:23], v[32:35]
  ds_read_b128 v[84:87], v4 offset:2304
  v_cvt_pk_bf16_f32 v58, v88, v89
  v_mfma_f32_16x16x32_bf16 v[36:39], v[200:203], v[20:23], v[36:39]
  v_cvt_pk_bf16_f32 v59, v90, v91
  ds_write_b128 v2, v[56:59] offset:256
  v_mfma_f32_16x16x32_bf16 v[40:43], v[204:207], v[20:23], v[40:43]
  ds_read_b128 v[88:91], v4 offset:2816
  v_lshlrev_b32 v72, 16, v60
  v_mfma_f32_16x16x32_bf16 v[44:47], v[208:211], v[20:23], v[44:47]
  v_and_b32 v73, s46, v60
  v_lshlrev_b32 v74, 16, v61
  v_mfma_f32_16x16x32_bf16 v[48:51], v[212:215], v[20:23], v[48:51]
  ds_read_b128 v[20:23], v3 offset:62976
  s_waitcnt lgkmcnt(5)
  buffer_store_dwordx4 v[12:15], v8, s[24:27], s43 offen sc1
  v_mfma_f32_16x16x32_bf16 v[32:35], v[216:219], v[24:27], v[32:35]
  s_add_u32 s43, s43, 20480
  ds_read_b128 v[12:15], v11 offset:3072
  v_and_b32 v75, s46, v61
  v_mfma_f32_16x16x32_bf16 v[36:39], v[220:223], v[24:27], v[36:39]
  v_fma_f32 v72, v72, v28, v30
  v_fma_f32 v73, v73, v28, v30
  v_mfma_f32_16x16x32_bf16 v[40:43], v[224:227], v[24:27], v[40:43]
  ds_write_b128 v6, v[92:95] offset:2048
  v_mfma_f32_16x16x32_bf16 v[44:47], v[228:231], v[24:27], v[44:47]
  v_fma_f32 v74, v74, v28, v30
  v_fma_f32 v75, v75, v28, v30
  v_mfma_f32_16x16x32_bf16 v[48:51], v[232:235], v[24:27], v[48:51]
  ds_read_b128 v[24:27], v3 offset:63040
  v_fmac_f32 v80, v72, v76
  s_waitcnt lgkmcnt(7)
  v_mfma_f32_16x16x32_bf16 v[32:35], v[236:239], v[16:19], v[32:35]
  ds_write_b128 v7, v[100:103] offset:2048
  v_mfma_f32_16x16x32_bf16 v[36:39], v[240:243], v[16:19], v[36:39]
  v_fmac_f32 v81, v73, v77
  s_nop 4
  v_cvt_pk_bf16_f32 v32, v32, v33
  v_mfma_f32_16x16x32_bf16 v[40:43], v[244:247], v[16:19], v[40:43]
  v_cvt_pk_bf16_f32 v33, v34, v35
  v_fmac_f32 v82, v74, v78
  v_mfma_f32_16x16x32_bf16 v[44:47], v[248:251], v[16:19], v[44:47]
  s_waitcnt lgkmcnt(3)
  buffer_store_dwordx4 v[12:15], v8, s[24:27], s39 offen sc1
  v_mfma_f32_16x16x32_bf16 v[48:51], v[252:255], v[16:19], v[48:51]
  s_add_u32 s39, s39, 20480
  ds_read_b128 v[16:19], v3 offset:63104
  v_cvt_pk_bf16_f32 v34, v36, v37
  v_mfma_f32_16x16x32_bf16 v[92:95], a[0:3], v[20:23], 0
  v_cvt_pk_bf16_f32 v35, v38, v39
  v_cvt_pk_bf16_f32 v40, v40, v41
  v_mfma_f32_16x16x32_bf16 v[96:99], a[4:7], v[20:23], 0
  v_cvt_pk_bf16_f32 v41, v42, v43
  v_cvt_pk_bf16_f32 v42, v44, v45
  v_mfma_f32_16x16x32_bf16 v[100:103], a[8:11], v[20:23], 0
  v_cvt_pk_bf16_f32 v43, v46, v47
  v_cvt_pk_bf16_f32 v48, v48, v49
  v_mfma_f32_16x16x32_bf16 v[104:107], a[12:15], v[20:23], 0
  v_cvt_pk_bf16_f32 v49, v50, v51
  v_permlane16_swap_b32 v32, v34
  v_mfma_f32_16x16x32_bf16 v[108:111], a[16:19], v[20:23], 0
  ds_read_b128 v[20:23], v3 offset:63168
  v_permlane16_swap_b32 v33, v35
  s_waitcnt lgkmcnt(3)
  v_mfma_f32_16x16x32_bf16 v[92:95], a[20:23], v[24:27], v[92:95]
  v_permlane16_swap_b32 v40, v42
  v_permlane16_swap_b32 v41, v43
  v_mfma_f32_16x16x32_bf16 v[96:99], a[24:27], v[24:27], v[96:99]
  ds_write_b64 v9, v[48:49] offset:8704
  v_mfma_f32_16x16x32_bf16 v[100:103], a[28:31], v[24:27], v[100:103]
  v_fmac_f32 v83, v75, v79
  ds_read_b128 v[76:79], v4 offset:3072
  v_mfma_f32_16x16x32_bf16 v[104:107], a[32:35], v[24:27], v[104:107]
  v_cvt_pk_bf16_f32 v60, v80, v81
  v_cvt_pk_bf16_f32 v61, v82, v83
  v_mfma_f32_16x16x32_bf16 v[108:111], a[36:39], v[24:27], v[108:111]
  ds_read_b128 v[24:27], v3 offset:63232
  ds_read_b128 v[12:15], v11
  s_waitcnt lgkmcnt(5)
  v_mfma_f32_16x16x32_bf16 v[92:95], a[40:43], v[16:19], v[92:95]
  ds_read_b128 v[80:83], v4 offset:3584
  v_lshlrev_b32 v72, 16, v62
  v_mfma_f32_16x16x32_bf16 v[96:99], a[44:47], v[16:19], v[96:99]
  v_and_b32 v73, s46, v62
  v_lshlrev_b32 v74, 16, v63
  v_mfma_f32_16x16x32_bf16 v[100:103], a[48:51], v[16:19], v[100:103]
  v_and_b32 v75, s46, v63
  v_fma_f32 v72, v72, v28, v30
  v_mfma_f32_16x16x32_bf16 v[104:107], a[52:55], v[16:19], v[104:107]
  v_fma_f32 v73, v73, v28, v30
  v_fma_f32 v74, v74, v28, v30
  v_mfma_f32_16x16x32_bf16 v[108:111], a[56:59], v[16:19], v[108:111]
  ds_read_b128 v[16:19], v3 offset:63296
  v_fma_f32 v75, v75, v28, v30
  s_waitcnt lgkmcnt(6)
  v_mfma_f32_16x16x32_bf16 v[92:95], a[60:63], v[20:23], v[92:95]
  v_fmac_f32 v88, v72, v84
  v_fmac_f32 v89, v73, v85
  v_mfma_f32_16x16x32_bf16 v[96:99], a[64:67], v[20:23], v[96:99]
  v_fmac_f32 v90, v74, v86
  v_fmac_f32 v91, v75, v87
  v_mfma_f32_16x16x32_bf16 v[100:103], a[68:71], v[20:23], v[100:103]
  s_waitcnt lgkmcnt(2)
  buffer_store_dwordx4 v[12:15], v8, s[24:27], s43 offen sc1
  v_mfma_f32_16x16x32_bf16 v[104:107], a[72:75], v[20:23], v[104:107]
  s_add_u32 s43, s43, 20480
  ds_read_b64 v[12:13], v10
  ds_read_b128 v[84:87], v4 offset:3328
  v_mfma_f32_16x16x32_bf16 v[108:111], a[76:79], v[20:23], v[108:111]
  ds_read_b128 v[20:23], v3 offset:63360
  v_cvt_pk_bf16_f32 v62, v88, v89
  v_mfma_f32_16x16x32_bf16 v[92:95], a[80:83], v[24:27], v[92:95]
  v_cvt_pk_bf16_f32 v63, v90, v91
  ds_write_b128 v2, v[60:63] offset:512
  v_mfma_f32_16x16x32_bf16 v[96:99], a[84:87], v[24:27], v[96:99]
  ds_read_b128 v[88:91], v4 offset:3840
  v_lshlrev_b32 v72, 16, v64
  v_mfma_f32_16x16x32_bf16 v[100:103], a[88:91], v[24:27], v[100:103]
  v_and_b32 v73, s46, v64
  v_lshlrev_b32 v74, 16, v65
  v_mfma_f32_16x16x32_bf16 v[104:107], a[92:95], v[24:27], v[104:107]
  v_and_b32 v75, s46, v65
  v_fma_f32 v72, v72, v28, v30
  v_mfma_f32_16x16x32_bf16 v[108:111], a[96:99], v[24:27], v[108:111]
  ds_read_b128 v[24:27], v3 offset:63424
  s_waitcnt lgkmcnt(5)
  buffer_store_dwordx2 v[12:13], v0, s[24:27], s44 offen sc1
  v_mfma_f32_16x16x32_bf16 v[92:95], a[100:103], v[16:19], v[92:95]
  s_add_u32 s44, s44, 20480
  ds_read_b128 v[12:15], v11 offset:1024
  v_fma_f32 v73, v73, v28, v30
  v_mfma_f32_16x16x32_bf16 v[96:99], a[104:107], v[16:19], v[96:99]
  v_fma_f32 v74, v74, v28, v30
  v_fma_f32 v75, v75, v28, v30
  v_mfma_f32_16x16x32_bf16 v[100:103], a[108:111], v[16:19], v[100:103]
  v_fmac_f32 v80, v72, v76
  v_fmac_f32 v81, v73, v77
  v_mfma_f32_16x16x32_bf16 v[104:107], a[112:115], v[16:19], v[104:107]
  ds_write_b128 v6, v[32:35]
  v_mfma_f32_16x16x32_bf16 v[108:111], a[116:119], v[16:19], v[108:111]
  ds_read_b128 v[16:19], v3 offset:63488
  v_fmac_f32 v82, v74, v78
  s_waitcnt lgkmcnt(6)
  v_mfma_f32_16x16x32_bf16 v[92:95], a[120:123], v[20:23], v[92:95]
  v_fmac_f32 v83, v75, v79
  ds_read_b128 v[76:79], v4 offset:4096
  v_mfma_f32_16x16x32_bf16 v[96:99], a[124:127], v[20:23], v[96:99]
  s_waitcnt lgkmcnt(3)
  buffer_store_dwordx4 v[12:15], v8, s[24:27], s39 offen sc1
  v_mfma_f32_16x16x32_bf16 v[100:103], a[128:131], v[20:23], v[100:103]
  s_add_u32 s39, s39, 20480
  v_cvt_pk_bf16_f32 v64, v80, v81
  v_cvt_pk_bf16_f32 v65, v82, v83
  v_mfma_f32_16x16x32_bf16 v[104:107], a[132:135], v[20:23], v[104:107]
  ds_read_b128 v[80:83], v4 offset:4608
  v_lshlrev_b32 v72, 16, v66
  v_mfma_f32_16x16x32_bf16 v[108:111], a[136:139], v[20:23], v[108:111]
  ds_read_b128 v[20:23], v3 offset:63552
  ds_read_b128 v[12:15], v11 offset:2048
  v_mfma_f32_16x16x32_bf16 v[92:95], a[140:143], v[24:27], v[92:95]
  ds_write_b128 v7, v[40:43]
  v_mfma_f32_16x16x32_bf16 v[96:99], a[144:147], v[24:27], v[96:99]
  v_and_b32 v73, s46, v66
  v_lshlrev_b32 v74, 16, v67
  v_mfma_f32_16x16x32_bf16 v[100:103], a[148:151], v[24:27], v[100:103]
  v_and_b32 v75, s46, v67
  v_fma_f32 v72, v72, v28, v30
  v_mfma_f32_16x16x32_bf16 v[104:107], a[152:155], v[24:27], v[104:107]
  v_fma_f32 v73, v73, v28, v30
  v_fma_f32 v74, v74, v28, v30
  v_mfma_f32_16x16x32_bf16 v[108:111], a[156:159], v[24:27], v[108:111]
  ds_read_b128 v[24:27], v3 offset:63616
  v_fma_f32 v75, v75, v28, v30
  s_waitcnt lgkmcnt(6)
  v_mfma_f32_16x16x32_bf16 v[92:95], a[160:163], v[16:19], v[92:95]
  v_fmac_f32 v88, v72, v84
  v_fmac_f32 v89, v73, v85
  v_mfma_f32_16x16x32_bf16 v[96:99], a[164:167], v[16:19], v[96:99]
  s_waitcnt lgkmcnt(2)
  buffer_store_dwordx4 v[12:15], v8, s[24:27], s43 offen sc1
  v_mfma_f32_16x16x32_bf16 v[100:103], a[168:171], v[16:19], v[100:103]
  s_add_u32 s43, s43, 20480
  ds_read_b64 v[14:15], v10 offset:2176
  v_fmac_f32 v90, v74, v86
  v_mfma_f32_16x16x32_bf16 v[104:107], a[172:175], v[16:19], v[104:107]
  v_fmac_f32 v91, v75, v87
  ds_read_b128 v[84:87], v4 offset:4352
  v_mfma_f32_16x16x32_bf16 v[108:111], a[176:179], v[16:19], v[108:111]
  ds_read_b128 v[16:19], v3 offset:63680
  v_cvt_pk_bf16_f32 v66, v88, v89
  v_mfma_f32_16x16x32_bf16 v[92:95], a[180:183], v[20:23], v[92:95]
  v_cvt_pk_bf16_f32 v67, v90, v91
  ds_write_b128 v2, v[64:67] offset:768
  v_mfma_f32_16x16x32_bf16 v[96:99], a[184:187], v[20:23], v[96:99]
  s_waitcnt vmcnt(12)
  ds_read_b128 v[52:55], v5 offset:26240
  s_waitcnt vmcnt(11)
  ds_read_b128 v[56:59], v5 offset:27552
  v_mfma_f32_16x16x32_bf16 v[100:103], a[188:191], v[20:23], v[100:103]
  s_waitcnt vmcnt(10)
  ds_read_b128 v[60:63], v5 offset:28864
  s_waitcnt vmcnt(9)
  ds_read_b128 v[64:67], v5 offset:30176
  v_mfma_f32_16x16x32_bf16 v[104:107], a[192:195], v[20:23], v[104:107]
  s_waitcnt lgkmcnt(7)
  buffer_store_dwordx2 v[14:15], v0, s[24:27], s44 offen sc1
  v_mfma_f32_16x16x32_bf16 v[108:111], a[196:199], v[20:23], v[108:111]
  s_add_u32 s44, s44, 20480
  ds_read_b128 v[20:23], v3 offset:63744
  ds_read_b128 v[12:15], v11 offset:3072
  v_mfma_f32_16x16x32_bf16 v[92:95], a[200:203], v[24:27], v[92:95]
  ds_read_b128 v[88:91], v4 offset:4864
  v_lshlrev_b32 v72, 16, v68
  v_mfma_f32_16x16x32_bf16 v[96:99], a[204:207], v[24:27], v[96:99]
  v_and_b32 v73, s46, v68
  v_lshlrev_b32 v74, 16, v69
  v_mfma_f32_16x16x32_bf16 v[100:103], a[208:211], v[24:27], v[100:103]
  v_and_b32 v75, s46, v69
  v_fma_f32 v72, v72, v28, v30
  v_mfma_f32_16x16x32_bf16 v[104:107], a[212:215], v[24:27], v[104:107]
  v_fma_f32 v73, v73, v28, v30
  v_fma_f32 v74, v74, v28, v30
  v_mfma_f32_16x16x32_bf16 v[108:111], a[216:219], v[24:27], v[108:111]
  ds_read_b128 v[24:27], v3 offset:63808
  v_fma_f32 v75, v75, v28, v30
  s_waitcnt lgkmcnt(9)
  v_mfma_f32_16x16x32_bf16 v[92:95], a[220:223], v[16:19], v[92:95]
  v_fmac_f32 v80, v72, v76
  v_fmac_f32 v81, v73, v77
  v_mfma_f32_16x16x32_bf16 v[96:99], a[224:227], v[16:19], v[96:99]
  v_fmac_f32 v82, v74, v78
  v_fmac_f32 v83, v75, v79
  v_mfma_f32_16x16x32_bf16 v[100:103], a[228:231], v[16:19], v[100:103]
  s_waitcnt lgkmcnt(2)
  buffer_store_dwordx4 v[12:15], v8, s[24:27], s39 offen sc1
  v_mfma_f32_16x16x32_bf16 v[104:107], a[232:235], v[16:19], v[104:107]
  s_add_u32 s39, s39, 20480
  ds_read_b128 v[76:79], v4 offset:0
  v_cvt_pk_bf16_f32 v68, v80, v81
  v_mfma_f32_16x16x32_bf16 v[108:111], a[236:239], v[16:19], v[108:111]
  ds_read_b128 v[16:19], v3 offset:63872
  ds_read_b128 v[12:15], v11
  v_mfma_f32_16x16x32_bf16 v[92:95], a[240:243], v[20:23], v[92:95]
  v_cvt_pk_bf16_f32 v69, v82, v83
  ds_read_b128 v[80:83], v4 offset:512
  v_mfma_f32_16x16x32_bf16 v[96:99], a[244:247], v[20:23], v[96:99]
  v_lshlrev_b32 v72, 16, v70
  v_and_b32 v73, s46, v70
  v_mfma_f32_16x16x32_bf16 v[100:103], a[248:251], v[20:23], v[100:103]
  v_lshlrev_b32 v74, 16, v71
  v_and_b32 v75, s46, v71
  v_mfma_f32_16x16x32_bf16 v[104:107], a[252:255], v[20:23], v[104:107]
  v_fma_f32 v72, v72, v28, v30
  v_fma_f32 v73, v73, v28, v30
  v_mfma_f32_16x16x32_bf16 v[108:111], v[112:115], v[20:23], v[108:111]
  ds_read_b128 v[20:23], v3 offset:63936
  v_fma_f32 v74, v74, v28, v30
  s_waitcnt lgkmcnt(5)
  v_mfma_f32_16x16x32_bf16 v[92:95], v[116:119], v[24:27], v[92:95]
  v_fma_f32 v75, v75, v28, v30
  v_fmac_f32 v88, v72, v84
  v_mfma_f32_16x16x32_bf16 v[96:99], v[120:123], v[24:27], v[96:99]
  v_fmac_f32 v89, v73, v85
  v_fmac_f32 v90, v74, v86
  v_mfma_f32_16x16x32_bf16 v[100:103], v[124:127], v[24:27], v[100:103]
  s_waitcnt lgkmcnt(2)
  buffer_store_dwordx4 v[12:15], v8, s[24:27], s43 offen sc1
  v_mfma_f32_16x16x32_bf16 v[104:107], v[128:131], v[24:27], v[104:107]
  s_add_u32 s43, s43, 20480
  ds_read_b64 v[12:13], v10 offset:4352
  v_fmac_f32 v91, v75, v87
  v_mfma_f32_16x16x32_bf16 v[108:111], v[132:135], v[24:27], v[108:111]
  ds_read_b128 v[24:27], v3 offset:64000
  ds_read_b128 v[84:87], v4 offset:256
  v_mfma_f32_16x16x32_bf16 v[92:95], v[136:139], v[16:19], v[92:95]
  v_cvt_pk_bf16_f32 v70, v88, v89
  v_cvt_pk_bf16_f32 v71, v90, v91
  v_mfma_f32_16x16x32_bf16 v[96:99], v[140:143], v[16:19], v[96:99]
  ds_write_b128 v2, v[68:71] offset:1024
  v_mfma_f32_16x16x32_bf16 v[100:103], v[144:147], v[16:19], v[100:103]
  s_waitcnt vmcnt(11)
  ds_read_b128 v[68:71], v5 offset:31488
  ds_read_b128 v[88:91], v4 offset:768
  v_mfma_f32_16x16x32_bf16 v[104:107], v[148:151], v[16:19], v[104:107]
  v_mov_b32 v29, 0
  v_mov_b32 v31, 0
  v_mfma_f32_16x16x32_bf16 v[108:111], v[152:155], v[16:19], v[108:111]
  ds_read_b128 v[16:19], v3 offset:64064
  s_waitcnt lgkmcnt(6)
  buffer_store_dwordx2 v[12:13], v0, s[24:27], s44 offen sc1
  v_mfma_f32_16x16x32_bf16 v[92:95], v[156:159], v[20:23], v[92:95]
  s_add_u32 s44, s44, 20480
  ds_read_b128 v[12:15], v11 offset:1024
  v_lshlrev_b32 v72, 16, v52
  v_mfma_f32_16x16x32_bf16 v[96:99], v[160:163], v[20:23], v[96:99]
  v_and_b32 v73, s46, v52
  v_lshlrev_b32 v74, 16, v53
  v_mfma_f32_16x16x32_bf16 v[100:103], v[164:167], v[20:23], v[100:103]
  v_and_b32 v75, s46, v53
  s_waitcnt lgkmcnt(3)
  v_dot2c_f32_bf16 v29, s47, v52
  v_dot2c_f32_bf16 v31, v52, v52
  v_dot2c_f32_bf16 v29, s47, v53
  v_dot2c_f32_bf16 v31, v53, v53
  v_dot2c_f32_bf16 v29, s47, v54
  v_dot2c_f32_bf16 v31, v54, v54
  v_dot2c_f32_bf16 v29, s47, v55
  v_dot2c_f32_bf16 v31, v55, v55
  v_dot2c_f32_bf16 v29, s47, v56
  v_dot2c_f32_bf16 v31, v56, v56
  v_dot2c_f32_bf16 v29, s47, v57
  v_dot2c_f32_bf16 v31, v57, v57
  v_dot2c_f32_bf16 v29, s47, v58
  v_dot2c_f32_bf16 v31, v58, v58
  s_waitcnt lgkmcnt(0)
  buffer_store_dwordx4 v[12:15], v8, s[24:27], s39 offen sc1
  s_add_u32 s39, s39, 20480
  v_dot2c_f32_bf16 v29, s47, v59
  v_dot2c_f32_bf16 v31, v59, v59
  v_dot2c_f32_bf16 v29, s47, v60
  v_dot2c_f32_bf16 v31, v60, v60
  v_dot2c_f32_bf16 v29, s47, v61
  v_dot2c_f32_bf16 v31, v61, v61
  v_dot2c_f32_bf16 v29, s47, v62
  v_dot2c_f32_bf16 v31, v62, v62
  v_dot2c_f32_bf16 v29, s47, v63
  v_dot2c_f32_bf16 v31, v63, v63
  v_dot2c_f32_bf16 v29, s47, v64
  v_dot2c_f32_bf16 v31, v64, v64
  v_dot2c_f32_bf16 v29, s47, v65
  v_dot2c_f32_bf16 v31, v65, v65
  v_dot2c_f32_bf16 v29, s47, v66
  v_dot2c_f32_bf16 v31, v66, v66
  v_dot2c_f32_bf16 v29, s47, v67
  v_dot2c_f32_bf16 v31, v67, v67
  v_dot2c_f32_bf16 v29, s47, v68
  v_dot2c_f32_bf16 v31, v68, v68
  v_dot2c_f32_bf16 v29, s47, v69
  v_dot2c_f32_bf16 v31, v69, v69
  v_dot2c_f32_bf16 v29, s47, v70
  v_dot2c_f32_bf16 v31, v70, v70
  v_dot2c_f32_bf16 v29, s47, v71
  v_dot2c_f32_bf16 v31, v71, v71
  v_mfma_f32_16x16x32_bf16 v[104:107], v[168:171], v[20:23], v[104:107]
  s_nop 0
  v_add_f32_dpp v29, v29, v29 row_ror:8 row_mask:0xf bank_mask:0xf
  v_add_f32_dpp v31, v31, v31 row_ror:8 row_mask:0xf bank_mask:0xf
  v_mfma_f32_16x16x32_bf16 v[108:111], v[172:175], v[20:23], v[108:111]
  ds_read_b128 v[20:23], v3 offset:64128
  v_add_f32_dpp v29, v29, v29 row_ror:4 row_mask:0xf bank_mask:0xf
  v_mfma_f32_16x16x32_bf16 v[92:95], v[176:179], v[24:27], v[92:95]
  v_add_f32_dpp v31, v31, v31 row_ror:4 row_mask:0xf bank_mask:0xf
  v_add_f32_dpp v29, v29, v29 row_ror:2 row_mask:0xf bank_mask:0xf
  v_mfma_f32_16x16x32_bf16 v[96:99], v[180:183], v[24:27], v[96:99]
  v_add_f32_dpp v31, v31, v31 row_ror:2 row_mask:0xf bank_mask:0xf
  v_add_f32_dpp v29, v29, v29 row_ror:1 row_mask:0xf bank_mask:0xf
  v_mfma_f32_16x16x32_bf16 v[100:103], v[184:187], v[24:27], v[100:103]
  v_add_f32_dpp v31, v31, v31 row_ror:1 row_mask:0xf bank_mask:0xf
  v_mul_f32 v28, v29, v29
  v_mfma_f32_16x16x32_bf16 v[104:107], v[188:191], v[24:27], v[104:107]
  v_fma_f32 v30, v29, v29, -v28
  v_fma_f32 v31, v31, s52, -v28
  v_mfma_f32_16x16x32_bf16 v[108:111], v[192:195], v[24:27], v[108:111]
  ds_read_b128 v[24:27], v3 offset:64192
  ds_read_b64 v[14:15], v10 offset:6528
  v_mfma_f32_16x16x32_bf16 v[92:95], v[196:199], v[16:19], v[92:95]
  v_sub_f32 v31, v31, v30
  v_max_f32 v31, 0, v31
  v_mfma_f32_16x16x32_bf16 v[96:99], v[200:203], v[16:19], v[96:99]
  v_add_f32 v31, s53, v31
  v_rsq_f32 v31, v31
  v_mfma_f32_16x16x32_bf16 v[100:103], v[204:207], v[16:19], v[100:103]
  v_mul_f32 v28, s52, v31
  v_fma_f32 v30, -v29, v31, 0
  v_mfma_f32_16x16x32_bf16 v[104:107], v[208:211], v[16:19], v[104:107]
  v_fma_f32 v72, v72, v28, v30
  v_fma_f32 v73, v73, v28, v30
  v_mfma_f32_16x16x32_bf16 v[108:111], v[212:215], v[16:19], v[108:111]
  v_fma_f32 v74, v74, v28, v30
  v_fma_f32 v75, v75, v28, v30
  s_waitcnt lgkmcnt(2)
  v_mfma_f32_16x16x32_bf16 v[92:95], v[216:219], v[20:23], v[92:95]
  v_fmac_f32 v80, v72, v76
  v_fmac_f32 v81, v73, v77
  v_mfma_f32_16x16x32_bf16 v[96:99], v[220:223], v[20:23], v[96:99]
  v_fmac_f32 v82, v74, v78
  s_waitcnt lgkmcnt(0)
  s_barrier
  v_mfma_f32_16x16x32_bf16 v[100:103], v[224:227], v[20:23], v[100:103]
  ds_read_b128 v[16:19], v3
  buffer_store_dwordx2 v[14:15], v0, s[24:27], s44 offen sc1
  v_mfma_f32_16x16x32_bf16 v[104:107], v[228:231], v[20:23], v[104:107]
  s_add_u32 s44, s44, 20480
  v_fmac_f32 v83, v75, v79
  ds_read_b128 v[76:79], v4 offset:1024
  v_mfma_f32_16x16x32_bf16 v[108:111], v[232:235], v[20:23], v[108:111]
  ds_read_b128 v[20:23], v3 offset:64
  v_cvt_pk_bf16_f32 v52, v80, v81
  v_mfma_f32_16x16x32_bf16 v[92:95], v[236:239], v[24:27], v[92:95]
  v_cvt_pk_bf16_f32 v53, v82, v83
  ds_read_b128 v[80:83], v4 offset:1536
  v_mfma_f32_16x16x32_bf16 v[96:99], v[240:243], v[24:27], v[96:99]
  v_lshlrev_b32 v72, 16, v54
  v_and_b32 v73, s46, v54
  v_mfma_f32_16x16x32_bf16 v[100:103], v[244:247], v[24:27], v[100:103]
  v_lshlrev_b32 v74, 16, v55
  v_and_b32 v75, s46, v55
  v_mfma_f32_16x16x32_bf16 v[104:107], v[248:251], v[24:27], v[104:107]
  v_fma_f32 v72, v72, v28, v30
  v_fma_f32 v73, v73, v28, v30
  v_mfma_f32_16x16x32_bf16 v[108:111], v[252:255], v[24:27], v[108:111]
  ds_read_b128 v[24:27], v3 offset:128
  v_fma_f32 v74, v74, v28, v30
  s_waitcnt lgkmcnt(4)
  v_mfma_f32_16x16x32_bf16 v[32:35], a[0:3], v[16:19], 0
  v_fma_f32 v75, v75, v28, v30
  v_fmac_f32 v88, v72, v84
  v_mfma_f32_16x16x32_bf16 v[36:39], a[4:7], v[16:19], 0
  v_fmac_f32 v89, v73, v85
  v_fmac_f32 v90, v74, v86
  v_mfma_f32_16x16x32_bf16 v[40:43], a[8:11], v[16:19], 0
  v_fmac_f32 v91, v75, v87
  ds_read_b128 v[84:87], v4 offset:1280
  v_mfma_f32_16x16x32_bf16 v[44:47], a[12:15], v[16:19], 0
  v_cvt_pk_bf16_f32 v54, v88, v89
  v_cvt_pk_bf16_f32 v55, v90, v91
  v_mfma_f32_16x16x32_bf16 v[48:51], a[16:19], v[16:19], 0
  ds_read_b128 v[16:19], v3 offset:192
  ds_read_b64 v[12:13], v10 offset:8704
  s_waitcnt lgkmcnt(5)
  v_mfma_f32_16x16x32_bf16 v[32:35], a[20:23], v[20:23], v[32:35]
  ds_write_b128 v2, v[52:55] offset:20992
  v_mfma_f32_16x16x32_bf16 v[36:39], a[24:27], v[20:23], v[36:39]
  ds_read_b128 v[88:91], v4 offset:1792
  v_lshlrev_b32 v72, 16, v56
  v_mfma_f32_16x16x32_bf16 v[40:43], a[28:31], v[20:23], v[40:43]
  v_and_b32 v73, s46, v56
  v_lshlrev_b32 v74, 16, v57
  v_mfma_f32_16x16x32_bf16 v[44:47], a[32:35], v[20:23], v[44:47]
  v_and_b32 v75, s46, v57
  v_fma_f32 v72, v72, v28, v30
  v_mfma_f32_16x16x32_bf16 v[48:51], a[36:39], v[20:23], v[48:51]
  ds_read_b128 v[20:23], v3 offset:256
  v_fma_f32 v73, v73, v28, v30
  s_waitcnt lgkmcnt(6)
  v_mfma_f32_16x16x32_bf16 v[32:35], a[40:43], v[24:27], v[32:35]
  s_waitcnt lgkmcnt(3)
  buffer_store_dwordx2 v[12:13], v0, s[24:27], s44 offen sc1
  v_mfma_f32_16x16x32_bf16 v[36:39], a[44:47], v[24:27], v[36:39]
  s_add_u32 s44, s44, 20480
  v_fma_f32 v74, v74, v28, v30
  v_fma_f32 v75, v75, v28, v30
  v_mfma_f32_16x16x32_bf16 v[40:43], a[48:51], v[24:27], v[40:43]
  v_fmac_f32 v80, v72, v76
  v_fmac_f32 v81, v73, v77
  v_mfma_f32_16x16x32_bf16 v[44:47], a[52:55], v[24:27], v[44:47]
  v_fmac_f32 v82, v74, v78
  v_fmac_f32 v83, v75, v79
  v_mfma_f32_16x16x32_bf16 v[48:51], a[56:59], v[24:27], v[48:51]
  ds_read_b128 v[24:27], v3 offset:320
  ds_read_b128 v[76:79], v4 offset:2048
  v_mfma_f32_16x16x32_bf16 v[32:35], a[60:63], v[16:19], v[32:35]
  v_cvt_pk_bf16_f32 v56, v80, v81
  v_cvt_pk_bf16_f32 v57, v82, v83
  v_mfma_f32_16x16x32_bf16 v[36:39], a[64:67], v[16:19], v[36:39]
  ds_read_b128 v[80:83], v4 offset:2560
  v_lshlrev_b32 v72, 16, v58
  v_mfma_f32_16x16x32_bf16 v[40:43], a[68:71], v[16:19], v[40:43]
  v_and_b32 v73, s46, v58
  v_lshlrev_b32 v74, 16, v59
  v_mfma_f32_16x16x32_bf16 v[44:47], a[72:75], v[16:19], v[44:47]
  v_and_b32 v75, s46, v59
  v_fma_f32 v72, v72, v28, v30
  v_mfma_f32_16x16x32_bf16 v[48:51], a[76:79], v[16:19], v[48:51]
  ds_read_b128 v[16:19], v3 offset:384
  v_fma_f32 v73, v73, v28, v30
  s_waitcnt lgkmcnt(4)
  v_mfma_f32_16x16x32_bf16 v[32:35], a[80:83], v[20:23], v[32:35]
  v_fma_f32 v74, v74, v28, v30
  v_fma_f32 v75, v75, v28, v30
  v_mfma_f32_16x16x32_bf16 v[36:39], a[84:87], v[20:23], v[36:39]
  v_fmac_f32 v88, v72, v84
  v_fmac_f32 v89, v73, v85
  v_mfma_f32_16x16x32_bf16 v[40:43], a[88:91], v[20:23], v[40:43]
  v_fmac_f32 v90, v74, v86
  v_fmac_f32 v91, v75, v87
  v_mfma_f32_16x16x32_bf16 v[44:47], a[92:95], v[20:23], v[44:47]
  ds_read_b128 v[84:87], v4 offset:2304
  v_cvt_pk_bf16_f32 v58, v88, v89
  v_mfma_f32_16x16x32_bf16 v[48:51], a[96:99], v[20:23], v[48:51]
  ds_read_b128 v[20:23], v3 offset:448
  v_cvt_pk_bf16_f32 v59, v90, v91
  s_waitcnt lgkmcnt(5)
  v_mfma_f32_16x16x32_bf16 v[32:35], a[100:103], v[24:27], v[32:35]
  ds_write_b128 v2, v[56:59] offset:21248
  v_mfma_f32_16x16x32_bf16 v[36:39], a[104:107], v[24:27], v[36:39]
  ds_read_b128 v[88:91], v4 offset:2816
  v_lshlrev_b32 v72, 16, v60
  v_mfma_f32_16x16x32_bf16 v[40:43], a[108:111], v[24:27], v[40:43]
  v_and_b32 v73, s46, v60
  v_lshlrev_b32 v74, 16, v61
  v_mfma_f32_16x16x32_bf16 v[44:47], a[112:115], v[24:27], v[44:47]
  v_and_b32 v75, s46, v61
  v_fma_f32 v72, v72, v28, v30
  v_mfma_f32_16x16x32_bf16 v[48:51], a[116:119], v[24:27], v[48:51]
  ds_read_b128 v[24:27], v3 offset:512
  v_fma_f32 v73, v73, v28, v30
  s_waitcnt lgkmcnt(5)
  v_mfma_f32_16x16x32_bf16 v[32:35], a[120:123], v[16:19], v[32:35]
  v_fma_f32 v74, v74, v28, v30
  v_fma_f32 v75, v75, v28, v30
  v_mfma_f32_16x16x32_bf16 v[36:39], a[124:127], v[16:19], v[36:39]
  v_fmac_f32 v80, v72, v76
  v_fmac_f32 v81, v73, v77
  v_mfma_f32_16x16x32_bf16 v[40:43], a[128:131], v[16:19], v[40:43]
  v_fmac_f32 v82, v74, v78
  v_fmac_f32 v83, v75, v79
  v_mfma_f32_16x16x32_bf16 v[44:47], a[132:135], v[16:19], v[44:47]
  ds_read_b128 v[76:79], v4 offset:3072
  v_cvt_pk_bf16_f32 v60, v80, v81
  v_mfma_f32_16x16x32_bf16 v[48:51], a[136:139], v[16:19], v[48:51]
  ds_read_b128 v[16:19], v3 offset:576
  v_cvt_pk_bf16_f32 v61, v82, v83
  s_waitcnt lgkmcnt(5)
  v_mfma_f32_16x16x32_bf16 v[32:35], a[140:143], v[20:23], v[32:35]
  ds_read_b128 v[80:83], v4 offset:3584
  v_lshlrev_b32 v72, 16, v62
  v_mfma_f32_16x16x32_bf16 v[36:39], a[144:147], v[20:23], v[36:39]
  v_and_b32 v73, s46, v62
  v_lshlrev_b32 v74, 16, v63
  v_mfma_f32_16x16x32_bf16 v[40:43], a[148:151], v[20:23], v[40:43]
  v_and_b32 v75, s46, v63
  v_fma_f32 v72, v72, v28, v30
  v_mfma_f32_16x16x32_bf16 v[44:47], a[152:155], v[20:23], v[44:47]
  v_fma_f32 v73, v73, v28, v30
  v_fma_f32 v74, v74, v28, v30
  v_mfma_f32_16x16x32_bf16 v[48:51], a[156:159], v[20:23], v[48:51]
  ds_read_b128 v[20:23], v3 offset:640
  v_fma_f32 v75, v75, v28, v30
  s_waitcnt lgkmcnt(4)
  v_mfma_f32_16x16x32_bf16 v[32:35], a[160:163], v[24:27], v[32:35]
  v_fmac_f32 v88, v72, v84
  v_fmac_f32 v89, v73, v85
  v_mfma_f32_16x16x32_bf16 v[36:39], a[164:167], v[24:27], v[36:39]
  v_fmac_f32 v90, v74, v86
  v_fmac_f32 v91, v75, v87
  v_mfma_f32_16x16x32_bf16 v[40:43], a[168:171], v[24:27], v[40:43]
  ds_read_b128 v[84:87], v4 offset:3328
  v_cvt_pk_bf16_f32 v62, v88, v89
  v_mfma_f32_16x16x32_bf16 v[44:47], a[172:175], v[24:27], v[44:47]
  v_cvt_pk_bf16_f32 v63, v90, v91
  ds_write_b128 v2, v[60:63] offset:21504
  v_mfma_f32_16x16x32_bf16 v[48:51], a[176:179], v[24:27], v[48:51]
  ds_read_b128 v[24:27], v3 offset:704
  ds_read_b128 v[88:91], v4 offset:3840
  s_waitcnt lgkmcnt(6)
  v_mfma_f32_16x16x32_bf16 v[32:35], a[180:183], v[16:19], v[32:35]
  v_lshlrev_b32 v72, 16, v64
  v_and_b32 v73, s46, v64
  v_mfma_f32_16x16x32_bf16 v[36:39], a[184:187], v[16:19], v[36:39]
  v_lshlrev_b32 v74, 16, v65
  v_and_b32 v75, s46, v65
  v_mfma_f32_16x16x32_bf16 v[40:43], a[188:191], v[16:19], v[40:43]
  v_fma_f32 v72, v72, v28, v30
  v_fma_f32 v73, v73, v28, v30
  v_mfma_f32_16x16x32_bf16 v[44:47], a[192:195], v[16:19], v[44:47]
  v_fma_f32 v74, v74, v28, v30
  v_fma_f32 v75, v75, v28, v30
  v_mfma_f32_16x16x32_bf16 v[48:51], a[196:199], v[16:19], v[48:51]
  ds_read_b128 v[16:19], v3 offset:768
  s_waitcnt lgkmcnt(6)
  v_fmac_f32 v80, v72, v76
  s_waitcnt lgkmcnt(5)
  v_mfma_f32_16x16x32_bf16 v[32:35], a[200:203], v[20:23], v[32:35]
  v_fmac_f32 v81, v73, v77
  v_fmac_f32 v82, v74, v78
  v_mfma_f32_16x16x32_bf16 v[36:39], a[204:207], v[20:23], v[36:39]
  v_fmac_f32 v83, v75, v79
  ds_read_b128 v[76:79], v4 offset:4096
  v_mfma_f32_16x16x32_bf16 v[40:43], a[208:211], v[20:23], v[40:43]
  v_cvt_pk_bf16_f32 v64, v80, v81
  v_cvt_pk_bf16_f32 v65, v82, v83
  v_mfma_f32_16x16x32_bf16 v[44:47], a[212:215], v[20:23], v[44:47]
  ds_read_b128 v[80:83], v4 offset:4608
  v_lshlrev_b32 v72, 16, v66
  v_mfma_f32_16x16x32_bf16 v[48:51], a[216:219], v[20:23], v[48:51]
  ds_read_b128 v[20:23], v3 offset:832
  v_and_b32 v73, s46, v66
  s_waitcnt lgkmcnt(5)
  v_mfma_f32_16x16x32_bf16 v[32:35], a[220:223], v[24:27], v[32:35]
  v_lshlrev_b32 v74, 16, v67
  v_and_b32 v75, s46, v67
  v_mfma_f32_16x16x32_bf16 v[36:39], a[224:227], v[24:27], v[36:39]
  v_fma_f32 v72, v72, v28, v30
  v_fma_f32 v73, v73, v28, v30
  v_mfma_f32_16x16x32_bf16 v[40:43], a[228:231], v[24:27], v[40:43]
  v_fma_f32 v74, v74, v28, v30
  v_fma_f32 v75, v75, v28, v30
  v_mfma_f32_16x16x32_bf16 v[44:47], a[232:235], v[24:27], v[44:47]
  s_waitcnt lgkmcnt(4)
  v_fmac_f32 v88, v72, v84
  v_fmac_f32 v89, v73, v85
  v_mfma_f32_16x16x32_bf16 v[48:51], a[236:239], v[24:27], v[48:51]
  ds_read_b128 v[24:27], v3 offset:896
  v_fmac_f32 v90, v74, v86
  s_waitcnt lgkmcnt(4)
  v_mfma_f32_16x16x32_bf16 v[32:35], a[240:243], v[16:19], v[32:35]
  v_fmac_f32 v91, v75, v87
  ds_read_b128 v[84:87], v4 offset:4352
  v_mfma_f32_16x16x32_bf16 v[36:39], a[244:247], v[16:19], v[36:39]
  v_cvt_pk_bf16_f32 v66, v88, v89
  v_cvt_pk_bf16_f32 v67, v90, v91
  v_mfma_f32_16x16x32_bf16 v[40:43], a[248:251], v[16:19], v[40:43]
  ds_write_b128 v2, v[64:67] offset:21760
  v_mfma_f32_16x16x32_bf16 v[44:47], a[252:255], v[16:19], v[44:47]
  ds_read_b128 v[88:91], v4 offset:4864
  v_lshlrev_b32 v72, 16, v68
  v_mfma_f32_16x16x32_bf16 v[48:51], v[112:115], v[16:19], v[48:51]
  ds_read_b128 v[16:19], v3 offset:960
  v_and_b32 v73, s46, v68
  s_waitcnt lgkmcnt(5)
  v_mfma_f32_16x16x32_bf16 v[32:35], v[116:119], v[20:23], v[32:35]
  v_lshlrev_b32 v74, 16, v69
  v_and_b32 v75, s46, v69
  v_mfma_f32_16x16x32_bf16 v[36:39], v[120:123], v[20:23], v[36:39]
  v_fma_f32 v72, v72, v28, v30
  v_fma_f32 v73, v73, v28, v30
  v_mfma_f32_16x16x32_bf16 v[40:43], v[124:127], v[20:23], v[40:43]
  v_fma_f32 v74, v74, v28, v30
  v_fma_f32 v75, v75, v28, v30
  v_mfma_f32_16x16x32_bf16 v[44:47], v[128:131], v[20:23], v[44:47]
  v_fmac_f32 v80, v72, v76
  v_fmac_f32 v81, v73, v77
  v_mfma_f32_16x16x32_bf16 v[48:51], v[132:135], v[20:23], v[48:51]
  ds_read_b128 v[20:23], v3 offset:1024
  v_fmac_f32 v82, v74, v78
  s_waitcnt lgkmcnt(5)
  v_mfma_f32_16x16x32_bf16 v[32:35], v[136:139], v[24:27], v[32:35]
  v_fmac_f32 v83, v75, v79
  v_cvt_pk_bf16_f32 v68, v80, v81
  v_mfma_f32_16x16x32_bf16 v[36:39], v[140:143], v[24:27], v[36:39]
  v_cvt_pk_bf16_f32 v69, v82, v83
  v_lshlrev_b32 v72, 16, v70
  v_mfma_f32_16x16x32_bf16 v[40:43], v[144:147], v[24:27], v[40:43]
  v_and_b32 v73, s46, v70
  v_lshlrev_b32 v74, 16, v71
  v_mfma_f32_16x16x32_bf16 v[44:47], v[148:151], v[24:27], v[44:47]
  v_and_b32 v75, s46, v71
  v_fma_f32 v72, v72, v28, v30
  v_mfma_f32_16x16x32_bf16 v[48:51], v[152:155], v[24:27], v[48:51]
  ds_read_b128 v[24:27], v3 offset:1088
  v_fma_f32 v73, v73, v28, v30
  s_waitcnt lgkmcnt(2)
  v_mfma_f32_16x16x32_bf16 v[32:35], v[156:159], v[16:19], v[32:35]
  v_fma_f32 v74, v74, v28, v30
  v_fma_f32 v75, v75, v28, v30
  v_mfma_f32_16x16x32_bf16 v[36:39], v[160:163], v[16:19], v[36:39]
  v_fmac_f32 v88, v72, v84
  v_fmac_f32 v89, v73, v85
  v_mfma_f32_16x16x32_bf16 v[40:43], v[164:167], v[16:19], v[40:43]
  v_fmac_f32 v90, v74, v86
  v_fmac_f32 v91, v75, v87
  v_mfma_f32_16x16x32_bf16 v[44:47], v[168:171], v[16:19], v[44:47]
  v_cvt_pk_bf16_f32 v70, v88, v89
  v_cvt_pk_bf16_f32 v71, v90, v91
  v_mfma_f32_16x16x32_bf16 v[48:51], v[172:175], v[16:19], v[48:51]
  ds_read_b128 v[16:19], v3 offset:1152
  ds_write_b128 v2, v[68:71] offset:22016
  s_waitcnt lgkmcnt(3)
  v_mfma_f32_16x16x32_bf16 v[32:35], v[176:179], v[20:23], v[32:35]
  v_cvt_pk_bf16_f32 v92, v92, v93
  v_cvt_pk_bf16_f32 v93, v94, v95
  v_mfma_f32_16x16x32_bf16 v[36:39], v[180:183], v[20:23], v[36:39]
  v_cvt_pk_bf16_f32 v94, v96, v97
  v_cvt_pk_bf16_f32 v95, v98, v99
  v_mfma_f32_16x16x32_bf16 v[40:43], v[184:187], v[20:23], v[40:43]
  v_cvt_pk_bf16_f32 v100, v100, v101
  v_cvt_pk_bf16_f32 v101, v102, v103
  v_mfma_f32_16x16x32_bf16 v[44:47], v[188:191], v[20:23], v[44:47]
  v_cvt_pk_bf16_f32 v102, v104, v105
  v_cvt_pk_bf16_f32 v103, v106, v107
  v_mfma_f32_16x16x32_bf16 v[48:51], v[192:195], v[20:23], v[48:51]
  ds_read_b128 v[20:23], v3 offset:1216
  v_cvt_pk_bf16_f32 v108, v108, v109
  s_waitcnt lgkmcnt(3)
  v_mfma_f32_16x16x32_bf16 v[32:35], v[196:199], v[24:27], v[32:35]
  v_cvt_pk_bf16_f32 v109, v110, v111
  ds_write_b64 v9, v[108:109]
  v_mfma_f32_16x16x32_bf16 v[36:39], v[200:203], v[24:27], v[36:39]
  s_waitcnt lgkmcnt(2)
  s_barrier
  v_mfma_f32_16x16x32_bf16 v[40:43], v[204:207], v[24:27], v[40:43]
  v_permlane16_swap_b32 v92, v94
  v_permlane16_swap_b32 v93, v95
  v_mfma_f32_16x16x32_bf16 v[44:47], v[208:211], v[24:27], v[44:47]
  ds_write_b128 v6, v[92:95] offset:2048
  v_mfma_f32_16x16x32_bf16 v[48:51], v[212:215], v[24:27], v[48:51]
  ds_read_b128 v[24:27], v3 offset:20992
  v_permlane16_swap_b32 v100, v102
  v_mfma_f32_16x16x32_bf16 v[32:35], v[216:219], v[16:19], v[32:35]
  v_permlane16_swap_b32 v101, v103
  v_mfma_f32_16x16x32_bf16 v[36:39], v[220:223], v[16:19], v[36:39]
  ds_write_b128 v7, v[100:103] offset:2048
  v_mfma_f32_16x16x32_bf16 v[40:43], v[224:227], v[16:19], v[40:43]
  ds_read_b128 v[96:99], v11 offset:2048
  ds_read_b128 v[104:107], v11 offset:3072
  v_mfma_f32_16x16x32_bf16 v[44:47], v[228:231], v[16:19], v[44:47]
  v_mfma_f32_16x16x32_bf16 v[48:51], v[232:235], v[16:19], v[48:51]
  ds_read_b128 v[16:19], v3 offset:21056
  s_waitcnt lgkmcnt(7)
  v_mfma_f32_16x16x32_bf16 v[32:35], v[236:239], v[20:23], v[32:35]
  v_mfma_f32_16x16x32_bf16 v[36:39], v[240:243], v[20:23], v[36:39]
  v_mfma_f32_16x16x32_bf16 v[40:43], v[244:247], v[20:23], v[40:43]
  s_nop 5
  v_cvt_pk_bf16_f32 v32, v32, v33
  v_mfma_f32_16x16x32_bf16 v[44:47], v[248:251], v[20:23], v[44:47]
  v_cvt_pk_bf16_f32 v33, v34, v35
  v_cvt_pk_bf16_f32 v34, v36, v37
  v_mfma_f32_16x16x32_bf16 v[48:51], v[252:255], v[20:23], v[48:51]
  ds_read_b128 v[20:23], v3 offset:21120
  v_cvt_pk_bf16_f32 v35, v38, v39
  s_waitcnt lgkmcnt(5)
  v_mfma_f32_16x16x32_bf16 v[52:55], a[0:3], v[24:27], 0
  v_cvt_pk_bf16_f32 v40, v40, v41
  v_cvt_pk_bf16_f32 v41, v42, v43
  v_mfma_f32_16x16x32_bf16 v[56:59], a[4:7], v[24:27], 0
  v_cvt_pk_bf16_f32 v42, v44, v45
  v_cvt_pk_bf16_f32 v43, v46, v47
  v_mfma_f32_16x16x32_bf16 v[60:63], a[8:11], v[24:27], 0
  v_cvt_pk_bf16_f32 v48, v48, v49
  v_cvt_pk_bf16_f32 v49, v50, v51
  v_mfma_f32_16x16x32_bf16 v[64:67], a[12:15], v[24:27], 0
  v_permlane16_swap_b32 v32, v34
  v_permlane16_swap_b32 v33, v35
  v_mfma_f32_16x16x32_bf16 v[68:71], a[16:19], v[24:27], 0
  ds_read_b128 v[24:27], v3 offset:21184
  ds_write_b128 v6, v[32:35]
  s_waitcnt lgkmcnt(3)
  v_mfma_f32_16x16x32_bf16 v[52:55], a[20:23], v[16:19], v[52:55]
  v_permlane16_swap_b32 v40, v42
  v_permlane16_swap_b32 v41, v43
  v_mfma_f32_16x16x32_bf16 v[56:59], a[24:27], v[16:19], v[56:59]
  v_mfma_f32_16x16x32_bf16 v[60:63], a[28:31], v[16:19], v[60:63]
  ds_write_b128 v7, v[40:43]
  v_mfma_f32_16x16x32_bf16 v[64:67], a[32:35], v[16:19], v[64:67]
  v_mfma_f32_16x16x32_bf16 v[68:71], a[36:39], v[16:19], v[68:71]
  ds_read_b128 v[16:19], v3 offset:21248
  s_waitcnt lgkmcnt(4)
  v_mfma_f32_16x16x32_bf16 v[52:55], a[40:43], v[20:23], v[52:55]
  ds_write_b64 v9, v[48:49] offset:2176
  v_mfma_f32_16x16x32_bf16 v[56:59], a[44:47], v[20:23], v[56:59]
  v_mfma_f32_16x16x32_bf16 v[60:63], a[48:51], v[20:23], v[60:63]
  v_mfma_f32_16x16x32_bf16 v[64:67], a[52:55], v[20:23], v[64:67]
  v_mfma_f32_16x16x32_bf16 v[68:71], a[56:59], v[20:23], v[68:71]
  ds_read_b128 v[20:23], v3 offset:21312
  ds_read_b128 v[36:39], v11
  s_waitcnt lgkmcnt(6)
  v_mfma_f32_16x16x32_bf16 v[52:55], a[60:63], v[24:27], v[52:55]
  buffer_store_dwordx4 v[96:99], v8, s[24:27], s43 offen sc1
  v_mfma_f32_16x16x32_bf16 v[56:59], a[64:67], v[24:27], v[56:59]
  s_add_u32 s43, s43, 20480
  v_mfma_f32_16x16x32_bf16 v[60:63], a[68:71], v[24:27], v[60:63]
  v_mfma_f32_16x16x32_bf16 v[64:67], a[72:75], v[24:27], v[64:67]
  buffer_store_dwordx4 v[104:107], v8, s[24:27], s39 offen sc1
  v_mfma_f32_16x16x32_bf16 v[68:71], a[76:79], v[24:27], v[68:71]
  s_add_u32 s39, s39, 20480
  ds_read_b128 v[24:27], v3 offset:21376
  s_waitcnt lgkmcnt(4)
  v_mfma_f32_16x16x32_bf16 v[52:55], a[80:83], v[16:19], v[52:55]
  v_mfma_f32_16x16x32_bf16 v[56:59], a[84:87], v[16:19], v[56:59]
  v_mfma_f32_16x16x32_bf16 v[60:63], a[88:91], v[16:19], v[60:63]
  v_mfma_f32_16x16x32_bf16 v[64:67], a[92:95], v[16:19], v[64:67]
  v_mfma_f32_16x16x32_bf16 v[68:71], a[96:99], v[16:19], v[68:71]
  ds_read_b128 v[16:19], v3 offset:21440
  s_waitcnt lgkmcnt(3)
  v_mfma_f32_16x16x32_bf16 v[52:55], a[100:103], v[20:23], v[52:55]
  v_mfma_f32_16x16x32_bf16 v[56:59], a[104:107], v[20:23], v[56:59]
  v_mfma_f32_16x16x32_bf16 v[60:63], a[108:111], v[20:23], v[60:63]
  v_mfma_f32_16x16x32_bf16 v[64:67], a[112:115], v[20:23], v[64:67]
  v_mfma_f32_16x16x32_bf16 v[68:71], a[116:119], v[20:23], v[68:71]
  ds_read_b128 v[20:23], v3 offset:21504
  ds_read_b128 v[44:47], v11 offset:1024
  s_waitcnt lgkmcnt(3)
  v_mfma_f32_16x16x32_bf16 v[52:55], a[120:123], v[24:27], v[52:55]
  v_mfma_f32_16x16x32_bf16 v[56:59], a[124:127], v[24:27], v[56:59]
  v_mfma_f32_16x16x32_bf16 v[60:63], a[128:131], v[24:27], v[60:63]
  v_mfma_f32_16x16x32_bf16 v[64:67], a[132:135], v[24:27], v[64:67]
  v_mfma_f32_16x16x32_bf16 v[68:71], a[136:139], v[24:27], v[68:71]
  s_barrier
  s_waitcnt lgkmcnt(2)
  v_mfma_f32_16x16x32_bf16 v[52:55], a[140:143], v[16:19], v[52:55]
  ds_read_b128 v[24:27], v3 offset:21568
  ds_read_b64 v[12:13], v10
  v_mfma_f32_16x16x32_bf16 v[56:59], a[144:147], v[16:19], v[56:59]
  ds_read_b64 v[14:15], v10 offset:2176
  v_mfma_f32_16x16x32_bf16 v[60:63], a[148:151], v[16:19], v[60:63]
  v_mfma_f32_16x16x32_bf16 v[64:67], a[152:155], v[16:19], v[64:67]
  v_mfma_f32_16x16x32_bf16 v[68:71], a[156:159], v[16:19], v[68:71]
  ds_read_b128 v[16:19], v3 offset:21632
  s_waitcnt lgkmcnt(5)
  v_mfma_f32_16x16x32_bf16 v[52:55], a[160:163], v[20:23], v[52:55]
  v_mfma_f32_16x16x32_bf16 v[56:59], a[164:167], v[20:23], v[56:59]
  v_mfma_f32_16x16x32_bf16 v[60:63], a[168:171], v[20:23], v[60:63]
  v_mfma_f32_16x16x32_bf16 v[64:67], a[172:175], v[20:23], v[64:67]
  s_waitcnt lgkmcnt(2)
  buffer_store_dwordx2 v[12:13], v0, s[24:27], s44 offen sc1
  v_mfma_f32_16x16x32_bf16 v[68:71], a[176:179], v[20:23], v[68:71]
  s_add_u32 s44, s44, 20480
  ds_read_b128 v[20:23], v3 offset:21696
  v_mfma_f32_16x16x32_bf16 v[52:55], a[180:183], v[24:27], v[52:55]
  v_mfma_f32_16x16x32_bf16 v[56:59], a[184:187], v[24:27], v[56:59]
  v_mfma_f32_16x16x32_bf16 v[60:63], a[188:191], v[24:27], v[60:63]
  s_waitcnt lgkmcnt(2)
  buffer_store_dwordx2 v[14:15], v0, s[24:27], s44 offen sc1
  v_mfma_f32_16x16x32_bf16 v[64:67], a[192:195], v[24:27], v[64:67]
  s_add_u32 s44, s44, 20480
  v_mfma_f32_16x16x32_bf16 v[68:71], a[196:199], v[24:27], v[68:71]
  ds_read_b128 v[24:27], v3 offset:21760
  s_waitcnt lgkmcnt(2)
  v_mfma_f32_16x16x32_bf16 v[52:55], a[200:203], v[16:19], v[52:55]
  v_mfma_f32_16x16x32_bf16 v[56:59], a[204:207], v[16:19], v[56:59]
  buffer_store_dwordx4 v[36:39], v8, s[24:27], s43 offen sc1
  v_mfma_f32_16x16x32_bf16 v[60:63], a[208:211], v[16:19], v[60:63]
  s_add_u32 s43, s43, 20480
  v_mfma_f32_16x16x32_bf16 v[64:67], a[212:215], v[16:19], v[64:67]
  v_mfma_f32_16x16x32_bf16 v[68:71], a[216:219], v[16:19], v[68:71]
  ds_read_b128 v[16:19], v3 offset:21824
  buffer_store_dwordx4 v[44:47], v8, s[24:27], s39 offen sc1
  s_waitcnt lgkmcnt(2)
  v_mfma_f32_16x16x32_bf16 v[52:55], a[220:223], v[20:23], v[52:55]
  s_add_u32 s39, s39, 20480
  v_mfma_f32_16x16x32_bf16 v[56:59], a[224:227], v[20:23], v[56:59]
  v_mfma_f32_16x16x32_bf16 v[60:63], a[228:231], v[20:23], v[60:63]
  v_mfma_f32_16x16x32_bf16 v[64:67], a[232:235], v[20:23], v[64:67]
  v_mfma_f32_16x16x32_bf16 v[68:71], a[236:239], v[20:23], v[68:71]
  ds_read_b128 v[20:23], v3 offset:21888
  s_waitcnt lgkmcnt(2)
  v_mfma_f32_16x16x32_bf16 v[52:55], a[240:243], v[24:27], v[52:55]
  v_mfma_f32_16x16x32_bf16 v[56:59], a[244:247], v[24:27], v[56:59]
  v_mfma_f32_16x16x32_bf16 v[60:63], a[248:251], v[24:27], v[60:63]
  v_mfma_f32_16x16x32_bf16 v[64:67], a[252:255], v[24:27], v[64:67]
  v_mfma_f32_16x16x32_bf16 v[68:71], v[112:115], v[24:27], v[68:71]
  ds_read_b128 v[24:27], v3 offset:21952
  s_waitcnt lgkmcnt(2)
  v_mfma_f32_16x16x32_bf16 v[52:55], v[116:119], v[16:19], v[52:55]
  v_mfma_f32_16x16x32_bf16 v[56:59], v[120:123], v[16:19], v[56:59]
  v_mfma_f32_16x16x32_bf16 v[60:63], v[124:127], v[16:19], v[60:63]
  v_mfma_f32_16x16x32_bf16 v[64:67], v[128:131], v[16:19], v[64:67]
  v_mfma_f32_16x16x32_bf16 v[68:71], v[132:135], v[16:19], v[68:71]
  ds_read_b128 v[16:19], v3 offset:22016
  s_waitcnt lgkmcnt(2)
  v_mfma_f32_16x16x32_bf16 v[52:55], v[136:139], v[20:23], v[52:55]
  v_mfma_f32_16x16x32_bf16 v[56:59], v[140:143], v[20:23], v[56:59]
  v_mfma_f32_16x16x32_bf16 v[60:63], v[144:147], v[20:23], v[60:63]
  v_mfma_f32_16x16x32_bf16 v[64:67], v[148:151], v[20:23], v[64:67]
  v_mfma_f32_16x16x32_bf16 v[68:71], v[152:155], v[20:23], v[68:71]
  ds_read_b128 v[20:23], v3 offset:22080
  s_waitcnt lgkmcnt(2)
  v_mfma_f32_16x16x32_bf16 v[52:55], v[156:159], v[24:27], v[52:55]
  v_mfma_f32_16x16x32_bf16 v[56:59], v[160:163], v[24:27], v[56:59]
  v_mfma_f32_16x16x32_bf16 v[60:63], v[164:167], v[24:27], v[60:63]
  v_mfma_f32_16x16x32_bf16 v[64:67], v[168:171], v[24:27], v[64:67]
  v_mfma_f32_16x16x32_bf16 v[68:71], v[172:175], v[24:27], v[68:71]
  ds_read_b128 v[24:27], v3 offset:22144
  s_waitcnt lgkmcnt(2)
  v_mfma_f32_16x16x32_bf16 v[52:55], v[176:179], v[16:19], v[52:55]
  v_mfma_f32_16x16x32_bf16 v[56:59], v[180:183], v[16:19], v[56:59]
  v_mfma_f32_16x16x32_bf16 v[60:63], v[184:187], v[16:19], v[60:63]
  v_mfma_f32_16x16x32_bf16 v[64:67], v[188:191], v[16:19], v[64:67]
  v_mfma_f32_16x16x32_bf16 v[68:71], v[192:195], v[16:19], v[68:71]
  ds_read_b128 v[16:19], v3 offset:22208
  s_waitcnt lgkmcnt(2)
  v_mfma_f32_16x16x32_bf16 v[52:55], v[196:199], v[20:23], v[52:55]
  v_mfma_f32_16x16x32_bf16 v[56:59], v[200:203], v[20:23], v[56:59]
  v_mfma_f32_16x16x32_bf16 v[60:63], v[204:207], v[20:23], v[60:63]
  v_mfma_f32_16x16x32_bf16 v[64:67], v[208:211], v[20:23], v[64:67]
  v_mfma_f32_16x16x32_bf16 v[68:71], v[212:215], v[20:23], v[68:71]
  s_waitcnt lgkmcnt(1)
  v_mfma_f32_16x16x32_bf16 v[52:55], v[216:219], v[24:27], v[52:55]
  v_mfma_f32_16x16x32_bf16 v[56:59], v[220:223], v[24:27], v[56:59]
  v_mfma_f32_16x16x32_bf16 v[60:63], v[224:227], v[24:27], v[60:63]
  v_mfma_f32_16x16x32_bf16 v[64:67], v[228:231], v[24:27], v[64:67]
  v_mfma_f32_16x16x32_bf16 v[68:71], v[232:235], v[24:27], v[68:71]
  s_waitcnt lgkmcnt(0)
  v_mfma_f32_16x16x32_bf16 v[52:55], v[236:239], v[16:19], v[52:55]
  v_mfma_f32_16x16x32_bf16 v[56:59], v[240:243], v[16:19], v[56:59]
  v_mfma_f32_16x16x32_bf16 v[60:63], v[244:247], v[16:19], v[60:63]
  s_nop 5
  v_cvt_pk_bf16_f32 v52, v52, v53
  v_mfma_f32_16x16x32_bf16 v[64:67], v[248:251], v[16:19], v[64:67]
  v_cvt_pk_bf16_f32 v53, v54, v55
  v_cvt_pk_bf16_f32 v54, v56, v57
  v_mfma_f32_16x16x32_bf16 v[68:71], v[252:255], v[16:19], v[68:71]
  v_cvt_pk_bf16_f32 v55, v58, v59
  v_cvt_pk_bf16_f32 v60, v60, v61
  v_cvt_pk_bf16_f32 v61, v62, v63
  v_permlane16_swap_b32 v52, v54
  v_permlane16_swap_b32 v53, v55
  v_cvt_pk_bf16_f32 v62, v64, v65
  v_cvt_pk_bf16_f32 v63, v66, v67
  ds_write_b128 v6, v[52:55] offset:2048
  v_cvt_pk_bf16_f32 v68, v68, v69
  v_cvt_pk_bf16_f32 v69, v70, v71
  v_permlane16_swap_b32 v60, v62
  v_permlane16_swap_b32 v61, v63
  ds_write_b128 v7, v[60:63] offset:2048
  ds_read_b128 v[56:59], v11 offset:2048
  ds_read_b128 v[64:67], v11 offset:3072
  ds_write_b64 v9, v[68:69] offset:4352
  s_waitcnt lgkmcnt(2)
  buffer_store_dwordx4 v[56:59], v8, s[24:27], s43 offen sc1
  s_add_u32 s43, s43, 20480
  s_waitcnt lgkmcnt(1)
  buffer_store_dwordx4 v[64:67], v8, s[24:27], s39 offen sc1
  s_waitcnt lgkmcnt(0)
  s_barrier
  s_add_u32 s39, s39, 20480
  ds_read_b64 v[14:15], v10 offset:4352
  s_waitcnt lgkmcnt(0)
  buffer_store_dwordx2 v[14:15], v0, s[24:27], s44 offen sc1
  s_add_u32 s44, s44, 20480
L_end:
  s_endpgm
.section .rodata,"a"
.p2align 6
.amdhsa_kernel standalone__layernorm_linear__sampling_kernel
  .amdhsa_next_free_vgpr 512
  .amdhsa_next_free_sgpr 64
  .amdhsa_accum_offset 256
  .amdhsa_group_segment_fixed_size 0
  .amdhsa_kernarg_size 56
  .amdhsa_user_sgpr_count 2
  .amdhsa_user_sgpr_kernarg_segment_ptr 1
  .amdhsa_system_sgpr_workgroup_id_x 1
.end_amdhsa_kernel
```
